```python
import torch

def _softmax(x, axis=-1):
    return torch.softmax(x, dim=axis)

def _gelu(x):
    return torch.nn.functional.gelu(x, approximate='tanh')

def _silu(x):
    return torch.nn.functional.silu(x)

def _sigmoid(x):
    return torch.sigmoid(x)

def _layernorm(x, axis=-1, eps=1e-05):
    m = x.mean(dim=axis, keepdim=True)
    v = x.var(dim=axis, keepdim=True, unbiased=False)
    return (x - m) / torch.sqrt(v + eps)

def _scatter_add(tgt, idx, src, axis=0):
    return tgt.clone().index_add_(axis, idx, src)

def _segment_sum(src, seg, n):
    out = torch.zeros((n,) + src.shape[1:], dtype=src.dtype)
    return out.index_add_(0, seg, src)

def _pad(x, pw):
    flat = tuple((v for pair in reversed(pw) for v in pair))
    return torch.nn.functional.pad(x, flat)
kernel_name = 'adaLN_cond__mha_block_cached__geglu_ffn__decode'

def setup_inputs():

    _w = lambda a: (lambda t: t.to(torch.bfloat16) if t.is_floating_point() else t)(torch.as_tensor(a))

    def _A_setup():
        B, Sq, D = (8, 1, 448)
        H, Sk, Dh = (16, 4096, 256)
        return {'x': _w((lambda *s: torch.randn(*s, dtype=torch.bfloat16) * 0.05)(B, Sq, D)), 'k_cache': _w((lambda *s: torch.randn(*s, dtype=torch.bfloat16) * 3.2)(B, H, Sk, Dh)), 'v_cache': _w((lambda *s: torch.randn(*s, dtype=torch.bfloat16) * 0.4)(B, H, Sk, Dh)), 'wq': _w((lambda *s: torch.randn(*s, dtype=torch.bfloat16) * 3.2)(D, H * Dh) * D ** (-0.5)), 'wo': _w((lambda *s: torch.randn(*s, dtype=torch.bfloat16) * 0.4)(H * Dh, D) * (H * Dh) ** (-0.5))}
    _A_in = _A_setup()

    def _B_setup():
        B, S, D, F = (8, 1, 448, 1792)
        return {'x': _w((lambda *s: torch.randn(*s, dtype=torch.bfloat16) * 0.05)(B, S, D)), 'w_gate': _w((lambda *s: torch.randn(*s, dtype=torch.bfloat16) * 0.05)(D, F)), 'w_up': _w((lambda *s: torch.randn(*s, dtype=torch.bfloat16) * 0.05)(D, F)), 'w_down': _w((lambda *s: torch.randn(*s, dtype=torch.bfloat16) * 0.05)(F, D))}
    _B_in = _B_setup()
    return {'A_x': _A_in['x'], 'A_k_cache': _A_in['k_cache'], 'A_v_cache': _A_in['v_cache'], 'A_wq': _A_in['wq'], 'A_wo': _A_in['wo'], 'B_x': _B_in['x'], 'B_w_gate': _B_in['w_gate'], 'B_w_up': _B_in['w_up'], 'B_w_down': _B_in['w_down'], 'c': _w((lambda *s: torch.randn(*s, dtype=torch.bfloat16) * 0.2)(8, 448) * 8.0), 'w_mod': _w((lambda *s: torch.randn(*s, dtype=torch.bfloat16) * 0.2)(448, 6 * 448) * 448 ** (-0.5) * 8.0)}

def reference(A_x, A_k_cache, A_v_cache, A_wq, A_wo, B_x, B_w_gate, B_w_up, B_w_down, c, w_mod):

    def _A_ref(x, k_cache, v_cache, wq, wo):
        B, Sq, D = x.shape
        H, Dh = (16, 256)
        q = (lambda x, *d: x.permute(*d))((x @ wq).reshape(B, Sq, H, Dh), 0, 2, 1, 3)
        scores = torch.einsum('bhqd,bhkd->bhqk', q, k_cache) * Dh ** (-0.5)
        p = _softmax(scores, axis=-1)
        o = torch.einsum('bhqk,bhkd->bhqd', p, v_cache)
        return (lambda x, *d: x.permute(*d))(o, 0, 2, 1, 3).reshape(B, Sq, H * Dh) @ wo

    def _B_ref(x, w_gate, w_up, w_down):
        return _gelu(x @ w_gate) * (x @ w_up) @ w_down
    x = A_x
    mod = (_silu(c) @ w_mod).reshape(c.shape[0], 6, 1, -1)
    sa, ca, ga, sb, cb, gb = (mod[:, 0].clone(), mod[:, 1].clone(), mod[:, 2].clone(), mod[:, 3].clone(), mod[:, 4].clone(), mod[:, 5].clone())
    h = _layernorm(x, axis=-1) * (1 + ca) + sa
    x = x + ga * _A_ref(h, A_k_cache, A_v_cache, A_wq, A_wo)
    h = _layernorm(x, axis=-1) * (1 + cb) + sb
    x = x + gb * _B_ref(h, B_w_gate, B_w_up, B_w_down)
    return x
```

```asm
; @launch grid=(256,1,1) block=(512,1,1) lds=163840
.amdgcn_target "amdgcn-amd-amdhsa--gfx950"
.text
.globl adaLN_cond__mha_block_cached__geglu_ffn__decode_kernel
.p2align 8
.type adaLN_cond__mha_block_cached__geglu_ffn__decode_kernel,@function
.set CODE_BYTES, L_CODE_END - adaLN_cond__mha_block_cached__geglu_ffn__decode_kernel - 64
adaLN_cond__mha_block_cached__geglu_ffn__decode_kernel:
  s_cmp_ge_u32 s2, 256
  s_cbranch_scc1 L_END
  s_getpc_b64 s[76:77]
  s_load_dwordx16 s[4:19], s[0:1], 0
  s_load_dwordx8 s[20:27], s[0:1], 64
  s_load_dwordx4 s[28:31], s[0:1], 96
  v_lshrrev_b32 v1, 6, v0
  v_and_b32 v0, 63, v0
  v_readfirstlane_b32 s39, v1
  s_and_b32 s34, s2, 7
  s_lshr_b32 s35, s2, 3
  s_and_b32 s36, s35, 1
  s_lshl_b32 s64, s34, 1
  s_add_u32 s36, s36, s64
  s_lshr_b32 s37, s35, 2
  s_lshr_b32 s38, s35, 1
  s_and_b32 s38, s38, 1
  s_sub_u32 s64, s39, 4
  s_cmp_ge_u32 s64, 2
  s_cbranch_scc1 L_cp_1
  s_mul_i32 s64, s64, 1024
  s_lshl_b32 s65, s35, 11
  s_add_u32 s64, s64, s65
  v_lshlrev_b32 v200, 4, v0
  v_add_u32 v200, s64, v200
  v_cmp_gt_u32 vcc, CODE_BYTES, v200
  s_and_saveexec_b64 s[74:75], vcc
  s_cbranch_execz L_cp_1_r
  global_load_dwordx4 v[204:207], v200, s[76:77]
L_cp_1_r:
  s_mov_b64 exec, s[74:75]
L_cp_1:
  s_cmp_eq_u32 s39, 4
  s_cbranch_scc0 L_nozero
  v_lshlrev_b32 v2, 2, v0
  v_mov_b32 v3, 0
  ds_write_b32 v2, v3
L_nozero:
  s_waitcnt lgkmcnt(0)
  s_load_dword s32, s[30:31], 0
  s_mov_b32 s44, s30
  s_mov_b32 s45, s31
  s_mov_b32 s46, 8388608
  s_mov_b32 s47, 0x20000
  s_cmp_ge_u32 s39, 4
  s_cbranch_scc1 L_HELPER
  s_lshl_b32 s64, s37, 4
  s_add_u32 s64, s64, s36
  s_lshl_b32 s64, s64, 21
  s_lshl_b32 s65, s38, 20
  s_add_u32 s65, s65, s64
  s_add_u32 s48, s6, s65
  s_addc_u32 s49, s7, 0
  s_mov_b32 s50, 0x100000
  s_mov_b32 s51, 0x20000
  s_add_u32 s52, s8, s64
  s_addc_u32 s53, s9, 0
  s_mov_b32 s54, 0x200000
  s_mov_b32 s55, 0x20000
  v_lshlrev_b32 v2, 4, v0
  s_lshl_b32 s56, s39, 10
  s_lshl_b32 s57, s39, 11
  s_barrier
  buffer_load_dwordx4 v[64:67], v2, s[48:51], s56 offen nt
  s_add_u32 s56, s56, 4096
  buffer_load_dwordx4 v[68:71], v2, s[48:51], s56 offen nt
  s_add_u32 s56, s56, 4096
  buffer_load_dwordx4 v[72:75], v2, s[48:51], s56 offen nt
  s_add_u32 s56, s56, 4096
  buffer_load_dwordx4 v[76:79], v2, s[48:51], s56 offen nt
  s_add_u32 s56, s56, 4096
  buffer_load_dwordx4 v[80:83], v2, s[48:51], s56 offen nt
  s_add_u32 s56, s56, 4096
  buffer_load_dwordx4 v[84:87], v2, s[48:51], s56 offen nt
  s_add_u32 s56, s56, 4096
  s_branch L_STREAM2
L_HELPER:
  s_sub_u32 s40, s39, 4
  s_mul_i32 s41, s40, 16384
  s_add_u32 s41, s41, 76544
  s_lshl_b32 s75, s40, 13
  s_add_u32 s75, s75, 131072
  v_and_b32 v1, 31, v0
  v_lshrrev_b32 v2, 5, v0
  v_lshrrev_b32 v3, 4, v0
  v_and_b32 v4, 15, v0
  v_lshlrev_b32 v10, 3, v3
  v_lshrrev_b32 v11, 2, v4
  v_add_u32 v10, v10, v11
  v_and_b32 v11, 3, v4
  v_lshlrev_b32 v11, 3, v11
  v_lshlrev_b32 v5, 5, v10
  v_add_u32 v5, v5, v11
  v_add_u32 v5, s41, v5
  v_mul_u32_u24 v6, 224, v10
  v_add_u32 v6, v6, v11
  v_add_u32 v6, s41, v6
  v_and_b32 v10, 7, v0
  v_mul_u32_u24 v7, 912, v10
  v_lshlrev_b32 v11, 4, v3
  v_add_u32 v7, v7, v11
  s_lshl_b32 s64, s40, 1
  v_add_u32 v10, s64, v2
  v_mul_u32_u24 v8, 912, v10
  v_lshlrev_b32 v11, 2, v1
  v_add_u32 v8, v8, v11
  v_lshlrev_b32 v9, 4, v0
  v_mul_u32_u24 v12, 896, v10
  v_add_u32 v12, v12, v11
  v_mul_u32_u24 v13, 10752, v10
  v_lshlrev_b32 v11, 3, v1
  v_add_u32 v13, v13, v11
  v_lshrrev_b32 v14, 1, v0
  v_and_b32 v15, 1, v0
  v_lshlrev_b32 v15, 4, v15
  v_mov_b32 v86, 0
  v_mov_b32 v87, 1
  s_lshr_b32 s64, s35, 1
  s_lshl_b32 s64, s64, 3
  s_add_u32 s64, s64, s34
  s_lshl_b32 s73, s64, 1
  s_and_b32 s65, s35, 1
  s_add_u32 s73, s73, s65
  s_cmp_lt_u32 s64, 42
  s_cselect_b32 s67, 1, 0
  s_cmp_lt_u32 s35, 12
  s_cselect_b32 s67, s67, 0
  s_cmp_ge_u32 s35, 16
  s_cselect_b32 s67, 2, s67
  s_cmp_eq_u32 s67, 0
  s_cbranch_scc0 L_hastile
  s_barrier
  s_branch L_pre_done
L_hastile:
  s_cmp_eq_u32 s67, 2
  s_cbranch_scc1 L_parq
  s_mov_b32 s56, s24
  s_mov_b32 s57, s25
  s_mov_b32 s58, 2408448
  s_mov_b32 s59, 0x20000
  s_movk_i32 s72, 5376
  s_lshl_b32 s66, s73, 6
  s_lshl_b32 s42, s73, 7
  s_add_u32 s42, s42, 4096
  s_movk_i32 s43, 10752
  s_branch L_pardone
L_parq:
  s_mov_b32 s56, s10
  s_mov_b32 s57, s11
  s_mov_b32 s58, 3670016
  s_mov_b32 s59, 0x20000
  s_movk_i32 s72, 8192
  s_sub_u32 s64, s35, 16
  s_lshl_b32 s65, s34, 4
  s_add_u32 s64, s64, s65
  s_lshl_b32 s66, s64, 6
  s_lshl_b32 s42, s64, 7
  s_add_u32 s42, s42, 131072
  s_movk_i32 s43, 16384
L_pardone:
  s_cmp_eq_u32 s67, 1
  s_cselect_b32 s48, s22, s4
  s_cselect_b32 s49, s23, s5
  s_movk_i32 s50, 7168
  s_mov_b32 s51, 0x20000
  buffer_load_dword v16, v12, s[48:51], 0 offen offset:0
  buffer_load_dword v17, v12, s[48:51], 0 offen offset:128
  buffer_load_dword v18, v12, s[48:51], 0 offen offset:256
  buffer_load_dword v19, v12, s[48:51], 0 offen offset:384
  buffer_load_dword v20, v12, s[48:51], 0 offen offset:512
  buffer_load_dword v21, v12, s[48:51], 0 offen offset:640
  buffer_load_dword v22, v12, s[48:51], 0 offen offset:768
  v_lshrrev_b32 v31, 2, v0
  v_mul_lo_u32 v31, v31, s72
  v_and_b32 v30, 3, v0
  v_lshlrev_b32 v30, 4, v30
  v_add_u32 v31, v31, v30
  s_lshl_b32 s64, s72, 5
  s_mul_i32 s65, s64, s40
  s_add_u32 s66, s66, s65
  s_lshl_b32 s65, s72, 4
  s_lshl_b32 s74, s72, 7
  s_sub_u32 s74, s74, s65
  s_add_u32 m0, s75, 0
  s_nop 0
  buffer_load_dwordx4 v31, s[56:59], s66 offen nt lds
  s_add_u32 s66, s66, s65
  s_add_u32 m0, s75, 1024
  s_nop 0
  buffer_load_dwordx4 v31, s[56:59], s66 offen nt lds
  s_add_u32 s66, s66, s74
  s_add_u32 m0, s75, 2048
  s_nop 0
  buffer_load_dwordx4 v31, s[56:59], s66 offen nt lds
  s_add_u32 s66, s66, s65
  s_add_u32 m0, s75, 3072
  s_nop 0
  buffer_load_dwordx4 v31, s[56:59], s66 offen nt lds
  s_add_u32 s66, s66, s74
  s_add_u32 m0, s75, 4096
  s_nop 0
  buffer_load_dwordx4 v31, s[56:59], s66 offen nt lds
  s_add_u32 s66, s66, s65
  s_add_u32 m0, s75, 5120
  s_nop 0
  buffer_load_dwordx4 v31, s[56:59], s66 offen nt lds
  s_add_u32 s66, s66, s74
  s_cmp_ge_u32 s40, 2
  s_cbranch_scc1 L_sk_9
  s_add_u32 m0, s75, 6144
  s_nop 0
  buffer_load_dwordx4 v31, s[56:59], s66 offen nt lds
  s_add_u32 s66, s66, s65
  s_add_u32 m0, s75, 7168
  s_nop 0
  buffer_load_dwordx4 v31, s[56:59], s66 offen nt lds
  s_add_u32 s66, s66, s74
L_sk_9:
  s_barrier
  v_lshlrev_b32 v24, 3, v3
  v_lshrrev_b32 v25, 2, v4
  v_add_u32 v24, v24, v25
  v_lshlrev_b32 v24, 6, v24
  v_and_b32 v25, 3, v4
  v_lshlrev_b32 v25, 3, v25
  v_add_u32 v24, v24, v25
  v_add_u32 v11, s75, v24
  s_waitcnt lgkmcnt(0)
  s_add_u32 s33, s32, 1
  s_mul_i32 s33, s33, 0x9E3779B1
  s_waitcnt vmcnt(6)
  s_cmp_eq_u32 s67, 2
  s_cbranch_scc1 L_actq
  v_lshlrev_b32 v32, 16, v16
  v_and_b32 v33, 0xffff0000, v16
  v_mul_f32 v34, 0xbfb8aa3b, v32
  v_exp_f32 v34, v34
  s_nop 0
  v_add_f32 v34, 1.0, v34
  v_rcp_f32 v34, v34
  s_nop 0
  v_mul_f32 v32, v32, v34
  v_mul_f32 v35, 0xbfb8aa3b, v33
  v_exp_f32 v35, v35
  s_nop 0
  v_add_f32 v35, 1.0, v35
  v_rcp_f32 v35, v35
  s_nop 0
  v_mul_f32 v33, v33, v35
  v_cvt_pk_bf16_f32 v36, v32, v33
  ds_write_b32 v8, v36 offset:256
  v_lshlrev_b32 v32, 16, v17
  v_and_b32 v33, 0xffff0000, v17
  v_mul_f32 v34, 0xbfb8aa3b, v32
  v_exp_f32 v34, v34
  s_nop 0
  v_add_f32 v34, 1.0, v34
  v_rcp_f32 v34, v34
  s_nop 0
  v_mul_f32 v32, v32, v34
  v_mul_f32 v35, 0xbfb8aa3b, v33
  v_exp_f32 v35, v35
  s_nop 0
  v_add_f32 v35, 1.0, v35
  v_rcp_f32 v35, v35
  s_nop 0
  v_mul_f32 v33, v33, v35
  v_cvt_pk_bf16_f32 v36, v32, v33
  ds_write_b32 v8, v36 offset:384
  v_lshlrev_b32 v32, 16, v18
  v_and_b32 v33, 0xffff0000, v18
  v_mul_f32 v34, 0xbfb8aa3b, v32
  v_exp_f32 v34, v34
  s_nop 0
  v_add_f32 v34, 1.0, v34
  v_rcp_f32 v34, v34
  s_nop 0
  v_mul_f32 v32, v32, v34
  v_mul_f32 v35, 0xbfb8aa3b, v33
  v_exp_f32 v35, v35
  s_nop 0
  v_add_f32 v35, 1.0, v35
  v_rcp_f32 v35, v35
  s_nop 0
  v_mul_f32 v33, v33, v35
  v_cvt_pk_bf16_f32 v36, v32, v33
  ds_write_b32 v8, v36 offset:512
  v_lshlrev_b32 v32, 16, v19
  v_and_b32 v33, 0xffff0000, v19
  v_mul_f32 v34, 0xbfb8aa3b, v32
  v_exp_f32 v34, v34
  s_nop 0
  v_add_f32 v34, 1.0, v34
  v_rcp_f32 v34, v34
  s_nop 0
  v_mul_f32 v32, v32, v34
  v_mul_f32 v35, 0xbfb8aa3b, v33
  v_exp_f32 v35, v35
  s_nop 0
  v_add_f32 v35, 1.0, v35
  v_rcp_f32 v35, v35
  s_nop 0
  v_mul_f32 v33, v33, v35
  v_cvt_pk_bf16_f32 v36, v32, v33
  ds_write_b32 v8, v36 offset:640
  v_lshlrev_b32 v32, 16, v20
  v_and_b32 v33, 0xffff0000, v20
  v_mul_f32 v34, 0xbfb8aa3b, v32
  v_exp_f32 v34, v34
  s_nop 0
  v_add_f32 v34, 1.0, v34
  v_rcp_f32 v34, v34
  s_nop 0
  v_mul_f32 v32, v32, v34
  v_mul_f32 v35, 0xbfb8aa3b, v33
  v_exp_f32 v35, v35
  s_nop 0
  v_add_f32 v35, 1.0, v35
  v_rcp_f32 v35, v35
  s_nop 0
  v_mul_f32 v33, v33, v35
  v_cvt_pk_bf16_f32 v36, v32, v33
  ds_write_b32 v8, v36 offset:768
  v_lshlrev_b32 v32, 16, v21
  v_and_b32 v33, 0xffff0000, v21
  v_mul_f32 v34, 0xbfb8aa3b, v32
  v_exp_f32 v34, v34
  s_nop 0
  v_add_f32 v34, 1.0, v34
  v_rcp_f32 v34, v34
  s_nop 0
  v_mul_f32 v32, v32, v34
  v_mul_f32 v35, 0xbfb8aa3b, v33
  v_exp_f32 v35, v35
  s_nop 0
  v_add_f32 v35, 1.0, v35
  v_rcp_f32 v35, v35
  s_nop 0
  v_mul_f32 v33, v33, v35
  v_cvt_pk_bf16_f32 v36, v32, v33
  ds_write_b32 v8, v36 offset:896
  v_lshlrev_b32 v32, 16, v22
  v_and_b32 v33, 0xffff0000, v22
  v_mul_f32 v34, 0xbfb8aa3b, v32
  v_exp_f32 v34, v34
  s_nop 0
  v_add_f32 v34, 1.0, v34
  v_rcp_f32 v34, v34
  s_nop 0
  v_mul_f32 v32, v32, v34
  v_mul_f32 v35, 0xbfb8aa3b, v33
  v_exp_f32 v35, v35
  s_nop 0
  v_add_f32 v35, 1.0, v35
  v_rcp_f32 v35, v35
  s_nop 0
  v_mul_f32 v33, v33, v35
  v_cvt_pk_bf16_f32 v36, v32, v33
  ds_write_b32 v8, v36 offset:1024
  s_branch L_actdone
L_actq:
  v_lshlrev_b32 v32, 16, v16
  v_and_b32 v33, 0xffff0000, v16
  v_lshlrev_b32 v34, 16, v17
  v_and_b32 v35, 0xffff0000, v17
  v_lshlrev_b32 v36, 16, v18
  v_and_b32 v37, 0xffff0000, v18
  v_lshlrev_b32 v38, 16, v19
  v_and_b32 v39, 0xffff0000, v19
  v_lshlrev_b32 v40, 16, v20
  v_and_b32 v41, 0xffff0000, v20
  v_lshlrev_b32 v42, 16, v21
  v_and_b32 v43, 0xffff0000, v21
  v_lshlrev_b32 v44, 16, v22
  v_and_b32 v45, 0xffff0000, v22
  v_add_f32 v46, v32, v33
  v_add_f32 v46, v46, v34
  v_add_f32 v46, v46, v35
  v_add_f32 v46, v46, v36
  v_add_f32 v46, v46, v37
  v_add_f32 v46, v46, v38
  v_add_f32 v46, v46, v39
  v_add_f32 v46, v46, v40
  v_add_f32 v46, v46, v41
  v_add_f32 v46, v46, v42
  v_add_f32 v46, v46, v43
  v_add_f32 v46, v46, v44
  v_add_f32 v46, v46, v45
  s_nop 1
  v_add_f32_dpp v46, v46, v46 quad_perm:[1,0,3,2] row_mask:0xf bank_mask:0xf
  s_nop 1
  v_add_f32_dpp v46, v46, v46 quad_perm:[2,3,0,1] row_mask:0xf bank_mask:0xf
  s_nop 1
  v_add_f32_dpp v46, v46, v46 row_half_mirror row_mask:0xf bank_mask:0xf
  s_nop 1
  v_add_f32_dpp v46, v46, v46 row_mirror row_mask:0xf bank_mask:0xf
  v_mov_b32 v47, v46
  s_nop 1
  v_permlane16_swap_b32 v46, v47
  v_add_f32 v46, v46, v47
  v_mul_f32 v48, 0x3b124925, v46
  v_sub_f32 v47, v32, v48
  v_mul_f32 v46, v47, v47
  v_sub_f32 v47, v33, v48
  v_fmac_f32 v46, v47, v47
  v_sub_f32 v47, v34, v48
  v_fmac_f32 v46, v47, v47
  v_sub_f32 v47, v35, v48
  v_fmac_f32 v46, v47, v47
  v_sub_f32 v47, v36, v48
  v_fmac_f32 v46, v47, v47
  v_sub_f32 v47, v37, v48
  v_fmac_f32 v46, v47, v47
  v_sub_f32 v47, v38, v48
  v_fmac_f32 v46, v47, v47
  v_sub_f32 v47, v39, v48
  v_fmac_f32 v46, v47, v47
  v_sub_f32 v47, v40, v48
  v_fmac_f32 v46, v47, v47
  v_sub_f32 v47, v41, v48
  v_fmac_f32 v46, v47, v47
  v_sub_f32 v47, v42, v48
  v_fmac_f32 v46, v47, v47
  v_sub_f32 v47, v43, v48
  v_fmac_f32 v46, v47, v47
  v_sub_f32 v47, v44, v48
  v_fmac_f32 v46, v47, v47
  v_sub_f32 v47, v45, v48
  v_fmac_f32 v46, v47, v47
  s_nop 1
  v_add_f32_dpp v46, v46, v46 quad_perm:[1,0,3,2] row_mask:0xf bank_mask:0xf
  s_nop 1
  v_add_f32_dpp v46, v46, v46 quad_perm:[2,3,0,1] row_mask:0xf bank_mask:0xf
  s_nop 1
  v_add_f32_dpp v46, v46, v46 row_half_mirror row_mask:0xf bank_mask:0xf
  s_nop 1
  v_add_f32_dpp v46, v46, v46 row_mirror row_mask:0xf bank_mask:0xf
  v_mov_b32 v47, v46
  s_nop 1
  v_permlane16_swap_b32 v46, v47
  v_add_f32 v46, v46, v47
  v_mul_f32 v46, 0x3b124925, v46
  v_cvt_pk_bf16_f32 v47, v48, v46
  v_lshlrev_b32 v48, 16, v47
  v_and_b32 v46, 0xffff0000, v47
  v_add_f32 v46, 0x3727c5ac, v46
  v_cvt_pk_bf16_f32 v46, v46, v46
  v_lshlrev_b32 v46, 16, v46
  v_sqrt_f32 v46, v46
  s_nop 0
  v_cvt_pk_bf16_f32 v46, v46, v46
  v_lshlrev_b32 v46, 16, v46
  v_rcp_f32 v49, v46
  v_sub_f32 v32, v32, v48
  v_sub_f32 v33, v33, v48
  v_cvt_pk_bf16_f32 v47, v32, v33
  v_lshlrev_b32 v32, 16, v47
  v_and_b32 v33, 0xffff0000, v47
  v_mul_f32 v32, v32, v49
  v_mul_f32 v33, v33, v49
  v_cvt_pk_bf16_f32 v16, v32, v33
  v_sub_f32 v34, v34, v48
  v_sub_f32 v35, v35, v48
  v_cvt_pk_bf16_f32 v47, v34, v35
  v_lshlrev_b32 v34, 16, v47
  v_and_b32 v35, 0xffff0000, v47
  v_mul_f32 v34, v34, v49
  v_mul_f32 v35, v35, v49
  v_cvt_pk_bf16_f32 v17, v34, v35
  v_sub_f32 v36, v36, v48
  v_sub_f32 v37, v37, v48
  v_cvt_pk_bf16_f32 v47, v36, v37
  v_lshlrev_b32 v36, 16, v47
  v_and_b32 v37, 0xffff0000, v47
  v_mul_f32 v36, v36, v49
  v_mul_f32 v37, v37, v49
  v_cvt_pk_bf16_f32 v18, v36, v37
  v_sub_f32 v38, v38, v48
  v_sub_f32 v39, v39, v48
  v_cvt_pk_bf16_f32 v47, v38, v39
  v_lshlrev_b32 v38, 16, v47
  v_and_b32 v39, 0xffff0000, v47
  v_mul_f32 v38, v38, v49
  v_mul_f32 v39, v39, v49
  v_cvt_pk_bf16_f32 v19, v38, v39
  v_sub_f32 v40, v40, v48
  v_sub_f32 v41, v41, v48
  v_cvt_pk_bf16_f32 v47, v40, v41
  v_lshlrev_b32 v40, 16, v47
  v_and_b32 v41, 0xffff0000, v47
  v_mul_f32 v40, v40, v49
  v_mul_f32 v41, v41, v49
  v_cvt_pk_bf16_f32 v20, v40, v41
  v_sub_f32 v42, v42, v48
  v_sub_f32 v43, v43, v48
  v_cvt_pk_bf16_f32 v47, v42, v43
  v_lshlrev_b32 v42, 16, v47
  v_and_b32 v43, 0xffff0000, v47
  v_mul_f32 v42, v42, v49
  v_mul_f32 v43, v43, v49
  v_cvt_pk_bf16_f32 v21, v42, v43
  v_sub_f32 v44, v44, v48
  v_sub_f32 v45, v45, v48
  v_cvt_pk_bf16_f32 v47, v44, v45
  v_lshlrev_b32 v44, 16, v47
  v_and_b32 v45, 0xffff0000, v47
  v_mul_f32 v44, v44, v49
  v_mul_f32 v45, v45, v49
  v_cvt_pk_bf16_f32 v22, v44, v45
  v_lshlrev_b32 v64, 16, v16
  v_and_b32 v65, 0xffff0000, v16
  v_lshlrev_b32 v66, 16, v17
  v_and_b32 v67, 0xffff0000, v17
  v_lshlrev_b32 v68, 16, v18
  v_and_b32 v69, 0xffff0000, v18
  v_lshlrev_b32 v70, 16, v19
  v_and_b32 v71, 0xffff0000, v19
  v_lshlrev_b32 v72, 16, v20
  v_and_b32 v73, 0xffff0000, v20
  v_lshlrev_b32 v74, 16, v21
  v_and_b32 v75, 0xffff0000, v21
  v_lshlrev_b32 v76, 16, v22
  v_and_b32 v77, 0xffff0000, v22
  s_mov_b32 s64, 7672
  v_mul_u32_u24 v24, 10752, v10
  s_mov_b64 exec, 1
  s_mov_b32 s71, 262144
L_p_10:
  buffer_load_dwordx2 v[32:33], v24, s[44:47], s64 offen sc1
  s_waitcnt vmcnt(0)
  v_xor_b32 v60, s33, v33
  v_cmp_ne_u32 vcc, 0, v60
  s_cbranch_vccz L_pd_11
  s_sub_u32 s71, s71, 1
  s_cmp_eq_u32 s71, 0
  s_cbranch_scc1 L_pd_11
  s_sleep 4
  s_branch L_p_10
L_pd_11:
  s_mov_b64 exec, -1
  s_mov_b32 s64, 4096
  s_mov_b32 s71, 262144
L_p_12:
  buffer_load_dwordx2 v[32:33], v13, s[44:47], s64 offen offset:0 sc1
  buffer_load_dwordx2 v[34:35], v13, s[44:47], s64 offen offset:256 sc1
  buffer_load_dwordx2 v[36:37], v13, s[44:47], s64 offen offset:512 sc1
  buffer_load_dwordx2 v[38:39], v13, s[44:47], s64 offen offset:768 sc1
  buffer_load_dwordx2 v[40:41], v13, s[44:47], s64 offen offset:1024 sc1
  buffer_load_dwordx2 v[42:43], v13, s[44:47], s64 offen offset:1280 sc1
  buffer_load_dwordx2 v[44:45], v13, s[44:47], s64 offen offset:1536 sc1
  buffer_load_dwordx2 v[46:47], v13, s[44:47], s64 offen offset:1792 sc1
  buffer_load_dwordx2 v[48:49], v13, s[44:47], s64 offen offset:2048 sc1
  buffer_load_dwordx2 v[50:51], v13, s[44:47], s64 offen offset:2304 sc1
  buffer_load_dwordx2 v[52:53], v13, s[44:47], s64 offen offset:2560 sc1
  buffer_load_dwordx2 v[54:55], v13, s[44:47], s64 offen offset:2816 sc1
  buffer_load_dwordx2 v[56:57], v13, s[44:47], s64 offen offset:3072 sc1
  buffer_load_dwordx2 v[58:59], v13, s[44:47], s64 offen offset:3328 sc1
  s_waitcnt vmcnt(0)
  v_xor_b32 v60, s33, v33
  v_xor_b32 v24, s33, v35
  v_or_b32 v60, v60, v24
  v_xor_b32 v24, s33, v37
  v_xor_b32 v25, s33, v39
  v_or3_b32 v60, v60, v24, v25
  v_xor_b32 v24, s33, v41
  v_xor_b32 v25, s33, v43
  v_or3_b32 v60, v60, v24, v25
  v_xor_b32 v24, s33, v45
  v_xor_b32 v25, s33, v47
  v_or3_b32 v60, v60, v24, v25
  v_xor_b32 v24, s33, v49
  v_xor_b32 v25, s33, v51
  v_or3_b32 v60, v60, v24, v25
  v_xor_b32 v24, s33, v53
  v_xor_b32 v25, s33, v55
  v_or3_b32 v60, v60, v24, v25
  v_xor_b32 v24, s33, v57
  v_xor_b32 v25, s33, v59
  v_or3_b32 v60, v60, v24, v25
  v_cmp_ne_u32 vcc, 0, v60
  s_cbranch_vccz L_pd_13
  s_sub_u32 s71, s71, 1
  s_cmp_eq_u32 s71, 0
  s_cbranch_scc1 L_pd_13
  s_sleep 4
  s_branch L_p_12
L_pd_13:
  v_lshlrev_b32 v24, 16, v46
  v_and_b32 v25, 0xffff0000, v46
  v_add_f32 v24, 1.0, v24
  v_add_f32 v25, 1.0, v25
  v_cvt_pk_bf16_f32 v26, v24, v25
  v_lshlrev_b32 v24, 16, v26
  v_and_b32 v25, 0xffff0000, v26
  v_mul_f32 v24, v24, v64
  v_mul_f32 v25, v25, v65
  v_cvt_pk_bf16_f32 v26, v24, v25
  v_lshlrev_b32 v24, 16, v26
  v_and_b32 v25, 0xffff0000, v26
  v_lshlrev_b32 v26, 16, v32
  v_and_b32 v27, 0xffff0000, v32
  v_add_f32 v24, v24, v26
  v_add_f32 v25, v25, v27
  v_cvt_pk_bf16_f32 v26, v24, v25
  ds_write_b32 v8, v26 offset:256
  v_lshlrev_b32 v24, 16, v48
  v_and_b32 v25, 0xffff0000, v48
  v_add_f32 v24, 1.0, v24
  v_add_f32 v25, 1.0, v25
  v_cvt_pk_bf16_f32 v26, v24, v25
  v_lshlrev_b32 v24, 16, v26
  v_and_b32 v25, 0xffff0000, v26
  v_mul_f32 v24, v24, v66
  v_mul_f32 v25, v25, v67
  v_cvt_pk_bf16_f32 v26, v24, v25
  v_lshlrev_b32 v24, 16, v26
  v_and_b32 v25, 0xffff0000, v26
  v_lshlrev_b32 v26, 16, v34
  v_and_b32 v27, 0xffff0000, v34
  v_add_f32 v24, v24, v26
  v_add_f32 v25, v25, v27
  v_cvt_pk_bf16_f32 v26, v24, v25
  ds_write_b32 v8, v26 offset:384
  v_lshlrev_b32 v24, 16, v50
  v_and_b32 v25, 0xffff0000, v50
  v_add_f32 v24, 1.0, v24
  v_add_f32 v25, 1.0, v25
  v_cvt_pk_bf16_f32 v26, v24, v25
  v_lshlrev_b32 v24, 16, v26
  v_and_b32 v25, 0xffff0000, v26
  v_mul_f32 v24, v24, v68
  v_mul_f32 v25, v25, v69
  v_cvt_pk_bf16_f32 v26, v24, v25
  v_lshlrev_b32 v24, 16, v26
  v_and_b32 v25, 0xffff0000, v26
  v_lshlrev_b32 v26, 16, v36
  v_and_b32 v27, 0xffff0000, v36
  v_add_f32 v24, v24, v26
  v_add_f32 v25, v25, v27
  v_cvt_pk_bf16_f32 v26, v24, v25
  ds_write_b32 v8, v26 offset:512
  v_lshlrev_b32 v24, 16, v52
  v_and_b32 v25, 0xffff0000, v52
  v_add_f32 v24, 1.0, v24
  v_add_f32 v25, 1.0, v25
  v_cvt_pk_bf16_f32 v26, v24, v25
  v_lshlrev_b32 v24, 16, v26
  v_and_b32 v25, 0xffff0000, v26
  v_mul_f32 v24, v24, v70
  v_mul_f32 v25, v25, v71
  v_cvt_pk_bf16_f32 v26, v24, v25
  v_lshlrev_b32 v24, 16, v26
  v_and_b32 v25, 0xffff0000, v26
  v_lshlrev_b32 v26, 16, v38
  v_and_b32 v27, 0xffff0000, v38
  v_add_f32 v24, v24, v26
  v_add_f32 v25, v25, v27
  v_cvt_pk_bf16_f32 v26, v24, v25
  ds_write_b32 v8, v26 offset:640
  v_lshlrev_b32 v24, 16, v54
  v_and_b32 v25, 0xffff0000, v54
  v_add_f32 v24, 1.0, v24
  v_add_f32 v25, 1.0, v25
  v_cvt_pk_bf16_f32 v26, v24, v25
  v_lshlrev_b32 v24, 16, v26
  v_and_b32 v25, 0xffff0000, v26
  v_mul_f32 v24, v24, v72
  v_mul_f32 v25, v25, v73
  v_cvt_pk_bf16_f32 v26, v24, v25
  v_lshlrev_b32 v24, 16, v26
  v_and_b32 v25, 0xffff0000, v26
  v_lshlrev_b32 v26, 16, v40
  v_and_b32 v27, 0xffff0000, v40
  v_add_f32 v24, v24, v26
  v_add_f32 v25, v25, v27
  v_cvt_pk_bf16_f32 v26, v24, v25
  ds_write_b32 v8, v26 offset:768
  v_lshlrev_b32 v24, 16, v56
  v_and_b32 v25, 0xffff0000, v56
  v_add_f32 v24, 1.0, v24
  v_add_f32 v25, 1.0, v25
  v_cvt_pk_bf16_f32 v26, v24, v25
  v_lshlrev_b32 v24, 16, v26
  v_and_b32 v25, 0xffff0000, v26
  v_mul_f32 v24, v24, v74
  v_mul_f32 v25, v25, v75
  v_cvt_pk_bf16_f32 v26, v24, v25
  v_lshlrev_b32 v24, 16, v26
  v_and_b32 v25, 0xffff0000, v26
  v_lshlrev_b32 v26, 16, v42
  v_and_b32 v27, 0xffff0000, v42
  v_add_f32 v24, v24, v26
  v_add_f32 v25, v25, v27
  v_cvt_pk_bf16_f32 v26, v24, v25
  ds_write_b32 v8, v26 offset:896
  v_lshlrev_b32 v24, 16, v58
  v_and_b32 v25, 0xffff0000, v58
  v_add_f32 v24, 1.0, v24
  v_add_f32 v25, 1.0, v25
  v_cvt_pk_bf16_f32 v26, v24, v25
  v_lshlrev_b32 v24, 16, v26
  v_and_b32 v25, 0xffff0000, v26
  v_mul_f32 v24, v24, v76
  v_mul_f32 v25, v25, v77
  v_cvt_pk_bf16_f32 v26, v24, v25
  v_lshlrev_b32 v24, 16, v26
  v_and_b32 v25, 0xffff0000, v26
  v_lshlrev_b32 v26, 16, v44
  v_and_b32 v27, 0xffff0000, v44
  v_add_f32 v24, v24, v26
  v_add_f32 v25, v25, v27
  v_cvt_pk_bf16_f32 v26, v24, v25
  ds_write_b32 v8, v26 offset:1024
L_actdone:
  s_waitcnt lgkmcnt(0)
  ds_add_u32 v86, v87 offset:0
  s_waitcnt vmcnt(0)
  ds_read_b64_tr_b16 v[88:89], v11 offset:0
  ds_read_b64_tr_b16 v[90:91], v11 offset:256
  ds_read_b64_tr_b16 v[92:93], v11 offset:32
  ds_read_b64_tr_b16 v[94:95], v11 offset:288
  ds_read_b64_tr_b16 v[96:97], v11 offset:2048
  ds_read_b64_tr_b16 v[98:99], v11 offset:2304
  ds_read_b64_tr_b16 v[100:101], v11 offset:2080
  ds_read_b64_tr_b16 v[102:103], v11 offset:2336
  ds_read_b64_tr_b16 v[104:105], v11 offset:4096
  ds_read_b64_tr_b16 v[106:107], v11 offset:4352
  ds_read_b64_tr_b16 v[108:109], v11 offset:4128
  ds_read_b64_tr_b16 v[110:111], v11 offset:4384
  s_cmp_ge_u32 s40, 2
  s_cbranch_scc1 L_sk_14
  ds_read_b64_tr_b16 v[112:113], v11 offset:6144
  ds_read_b64_tr_b16 v[114:115], v11 offset:6400
  ds_read_b64_tr_b16 v[116:117], v11 offset:6176
  ds_read_b64_tr_b16 v[118:119], v11 offset:6432
L_sk_14:
L_w_15:
  ds_read_b32 v50, v86 offset:0
  s_waitcnt lgkmcnt(0)
  v_readfirstlane_b32 s70, v50
  s_cmp_ge_u32 s70, 256
  s_cbranch_scc1 L_wd_16
  s_sleep 1
  s_branch L_w_15
L_wd_16:
  s_lshl_b32 s64, s40, 6
  v_add_u32 v50, s64, v7
  ds_read_b128 v[120:123], v50 offset:256
  ds_read_b128 v[124:127], v50 offset:512
  ds_read_b128 v[128:131], v50 offset:768
  s_cmp_ge_u32 s40, 2
  s_cbranch_scc1 L_sk_17
  ds_read_b128 v[132:135], v50 offset:1024
L_sk_17:
  s_waitcnt lgkmcnt(0)
  v_mfma_f32_16x16x32_bf16 v[136:139], v[88:91], v[120:123], 0
  v_mfma_f32_16x16x32_bf16 v[140:143], v[92:95], v[120:123], 0
  v_mfma_f32_16x16x32_bf16 v[136:139], v[96:99], v[124:127], v[136:139]
  v_mfma_f32_16x16x32_bf16 v[140:143], v[100:103], v[124:127], v[140:143]
  v_mfma_f32_16x16x32_bf16 v[136:139], v[104:107], v[128:131], v[136:139]
  v_mfma_f32_16x16x32_bf16 v[140:143], v[108:111], v[128:131], v[140:143]
  s_cmp_ge_u32 s40, 2
  s_cbranch_scc1 L_sk_18
  v_mfma_f32_16x16x32_bf16 v[136:139], v[112:115], v[132:135], v[136:139]
  v_mfma_f32_16x16x32_bf16 v[140:143], v[116:119], v[132:135], v[140:143]
L_sk_18:
  s_lshl_b32 s64, s40, 11
  v_add_u32 v50, s64, v9
  s_nop 4
  ds_write_b128 v50, v[136:139] offset:7552
  ds_write_b128 v50, v[140:143] offset:8576
  s_waitcnt lgkmcnt(0)
  ds_add_u32 v86, v87 offset:4
  s_cmp_ge_u32 s40, 2
  s_cbranch_scc1 L_pre_done
L_w_19:
  ds_read_b32 v50, v86 offset:4
  s_waitcnt lgkmcnt(0)
  v_readfirstlane_b32 s70, v50
  s_cmp_ge_u32 s70, 256
  s_cbranch_scc1 L_wd_20
  s_sleep 1
  s_branch L_w_19
L_wd_20:
  s_lshl_b32 s64, s40, 10
  v_add_u32 v51, s64, v9
  ds_read_b128 v[32:35], v51 offset:7552
  ds_read_b128 v[36:39], v51 offset:9600
  ds_read_b128 v[40:43], v51 offset:11648
  ds_read_b128 v[44:47], v51 offset:13696
  s_waitcnt lgkmcnt(0)
  v_add_f32 v48, v32, v36
  v_add_f32 v48, v48, v40
  v_add_f32 v48, v48, v44
  v_add_f32 v49, v33, v37
  v_add_f32 v49, v49, v41
  v_add_f32 v49, v49, v45
  v_add_f32 v50, v34, v38
  v_add_f32 v50, v50, v42
  v_add_f32 v50, v50, v46
  v_add_f32 v51, v35, v39
  v_add_f32 v51, v51, v43
  v_add_f32 v51, v51, v47
  s_lshl_b32 s64, s40, 6
  s_add_u32 s64, s64, s42
  v_cvt_pk_bf16_f32 v52, v48, v49
  v_cvt_pk_bf16_f32 v54, v50, v51
  v_mov_b32 v53, s33
  v_mov_b32 v55, s33
  v_mul_lo_u32 v56, v4, s43
  v_lshlrev_b32 v57, 4, v3
  v_add_u32 v56, v56, v57
  s_mov_b32 exec_lo, 0x00ff00ff
  s_mov_b32 exec_hi, 0x00ff00ff
  buffer_store_dwordx4 v[52:55], v56, s[44:47], s64 offen sc1
  s_mov_b64 exec, -1
L_pre_done:
  s_waitcnt lgkmcnt(0)
  s_add_u32 s33, s32, 1
  s_mul_i32 s33, s33, 0x9E3779B1
  s_branch L_HPOST
L_STREAM2:
  v_lshrrev_b32 v4, 4, v0
  v_lshlrev_b32 v3, 9, v4
  v_and_b32 v5, 15, v0
  v_lshlrev_b32 v5, 4, v5
  v_add_u32 v3, v3, v5
  s_lshl_b32 s64, s38, 8
  v_add_u32 v3, s64, v3
  v_and_b32 v5, 31, v0
  v_lshlrev_b32 v5, 5, v5
  s_lshl_b32 s64, s37, 14
  s_lshl_b32 s65, s36, 10
  s_add_u32 s66, s64, s65
  s_add_u32 s66, s66, 131072
  s_mov_b32 s60, 0xcccccccc
  s_mov_b32 s61, 0xcccccccc
  s_mov_b32 s62, 0xaaaaaaaa
  s_mov_b32 s63, 0xaaaaaaaa
  v_mov_b32 v6, 0
  v_mov_b32 v7, 1
  v_mul_u32_u24 v16, 144, v0
  s_lshl_b32 s64, s39, 2
  v_add_u32 v16, s64, v16
  s_lshl_b32 s64, s39, 2
  v_add_u32 v17, s64, v4
  v_mul_u32_u24 v17, 1040, v17
  s_mul_i32 s59, s39, 25600
  s_add_u32 s59, s59, 27136
  v_add_u32 v33, s59, v2
  s_waitcnt vmcnt(5)
  buffer_load_dwordx4 v[88:91], v2, s[48:51], s56 offen nt
  s_add_u32 s56, s56, 4096
  s_waitcnt vmcnt(5)
  buffer_load_dwordx4 v[92:95], v2, s[48:51], s56 offen nt
  s_add_u32 s56, s56, 4096
  s_waitcnt vmcnt(5)
  buffer_load_dwordx4 v[96:99], v2, s[48:51], s56 offen nt
  s_add_u32 s56, s56, 4096
  s_waitcnt vmcnt(5)
  buffer_load_dwordx4 v[100:103], v2, s[48:51], s56 offen nt
  s_add_u32 s56, s56, 4096
  s_waitcnt vmcnt(5)
  buffer_load_dwordx4 v[104:107], v2, s[48:51], s56 offen nt
  s_add_u32 s56, s56, 4096
  s_waitcnt vmcnt(5)
  buffer_load_dwordx4 v[108:111], v2, s[48:51], s56 offen nt
  s_add_u32 s56, s56, 4096
  s_waitcnt vmcnt(5)
  buffer_load_dwordx4 v[112:115], v2, s[48:51], s56 offen nt
  s_add_u32 s56, s56, 4096
  s_waitcnt vmcnt(5)
  buffer_load_dwordx4 v[116:119], v2, s[48:51], s56 offen nt
  s_add_u32 s56, s56, 4096
  s_waitcnt vmcnt(5)
  buffer_load_dwordx4 v[120:123], v2, s[48:51], s56 offen nt
  s_add_u32 s56, s56, 4096
  s_waitcnt vmcnt(5)
  buffer_load_dwordx4 v[124:127], v2, s[48:51], s56 offen nt
  s_add_u32 s56, s56, 4096
  s_waitcnt vmcnt(5)
  buffer_load_dwordx4 v[128:131], v2, s[48:51], s56 offen nt
  s_add_u32 s56, s56, 4096
  s_waitcnt vmcnt(5)
  buffer_load_dwordx4 v[132:135], v2, s[48:51], s56 offen nt
  s_add_u32 s56, s56, 4096
  s_waitcnt vmcnt(5)
  buffer_load_dwordx4 v[136:139], v2, s[48:51], s56 offen nt
  s_add_u32 s56, s56, 4096
  s_waitcnt vmcnt(5)
  buffer_load_dwordx4 v[140:143], v2, s[48:51], s56 offen nt
  s_add_u32 s56, s56, 4096
  s_waitcnt vmcnt(5)
  buffer_load_dwordx4 v[144:147], v2, s[48:51], s56 offen nt
  s_add_u32 s56, s56, 4096
  s_waitcnt vmcnt(5)
  buffer_load_dwordx4 v[148:151], v2, s[48:51], s56 offen nt
  s_add_u32 s56, s56, 4096
  s_waitcnt vmcnt(5)
  buffer_load_dwordx4 v[152:155], v2, s[48:51], s56 offen nt
  s_add_u32 s56, s56, 4096
  s_waitcnt vmcnt(5)
  buffer_load_dwordx4 v[156:159], v2, s[48:51], s56 offen nt
  s_add_u32 s56, s56, 4096
  s_waitcnt vmcnt(5)
  buffer_load_dwordx4 v[160:163], v2, s[48:51], s56 offen nt
  s_add_u32 s56, s56, 4096
  s_waitcnt vmcnt(5)
  buffer_load_dwordx4 v[164:167], v2, s[48:51], s56 offen nt
  s_add_u32 s56, s56, 4096
  s_waitcnt vmcnt(5)
  buffer_load_dwordx4 v[168:171], v2, s[48:51], s56 offen nt
  s_add_u32 s56, s56, 4096
  s_waitcnt vmcnt(5)
  buffer_load_dwordx4 v[172:175], v2, s[48:51], s56 offen nt
  s_add_u32 s56, s56, 4096
  s_waitcnt vmcnt(5)
  buffer_load_dwordx4 v[176:179], v2, s[48:51], s56 offen nt
  s_add_u32 s56, s56, 4096
  s_waitcnt vmcnt(5)
  buffer_load_dwordx4 v[180:183], v2, s[48:51], s56 offen nt
  s_add_u32 s56, s56, 4096
  s_waitcnt vmcnt(5)
  buffer_load_dwordx4 v[184:187], v2, s[48:51], s56 offen nt
  s_add_u32 s56, s56, 4096
  s_waitcnt vmcnt(5)
  buffer_load_dwordx4 v[188:191], v2, s[48:51], s56 offen nt
  s_add_u32 s56, s56, 4096
  s_waitcnt vmcnt(5)
  buffer_load_dwordx4 v[192:195], v2, s[48:51], s56 offen nt
  s_add_u32 s56, s56, 4096
  s_waitcnt vmcnt(5)
  buffer_load_dwordx4 v[196:199], v2, s[48:51], s56 offen nt
  s_add_u32 s56, s56, 4096
  s_waitcnt vmcnt(5)
  buffer_load_dwordx4 v[200:203], v2, s[48:51], s56 offen nt
  s_add_u32 s56, s56, 4096
  s_waitcnt vmcnt(5)
  buffer_load_dwordx4 v[204:207], v2, s[48:51], s56 offen nt
  s_add_u32 s56, s56, 4096
  s_waitcnt vmcnt(5)
  buffer_load_dwordx4 v[208:211], v2, s[48:51], s56 offen nt
  s_add_u32 s56, s56, 4096
  s_waitcnt vmcnt(5)
  buffer_load_dwordx4 v[212:215], v2, s[48:51], s56 offen nt
  s_add_u32 s56, s56, 4096
  s_waitcnt vmcnt(5)
  buffer_load_dwordx4 v[216:219], v2, s[48:51], s56 offen nt
  s_add_u32 s56, s56, 4096
  s_waitcnt vmcnt(5)
  buffer_load_dwordx4 v[220:223], v2, s[48:51], s56 offen nt
  s_add_u32 s56, s56, 4096
  s_waitcnt vmcnt(5)
  buffer_load_dwordx4 v[224:227], v2, s[48:51], s56 offen nt
  s_add_u32 s56, s56, 4096
  s_waitcnt vmcnt(5)
  buffer_load_dwordx4 v[228:231], v2, s[48:51], s56 offen nt
  s_add_u32 s56, s56, 4096
  s_waitcnt vmcnt(5)
  buffer_load_dwordx4 v[232:235], v2, s[48:51], s56 offen nt
  s_add_u32 s56, s56, 4096
  s_waitcnt vmcnt(5)
  buffer_load_dwordx4 v[236:239], v2, s[48:51], s56 offen nt
  s_add_u32 s56, s56, 4096
  s_waitcnt vmcnt(5)
  buffer_load_dwordx4 v[240:243], v2, s[48:51], s56 offen nt
  s_add_u32 s56, s56, 4096
  s_waitcnt vmcnt(5)
  buffer_load_dwordx4 v[244:247], v2, s[48:51], s56 offen nt
  s_add_u32 s56, s56, 4096
  s_waitcnt vmcnt(5)
  buffer_load_dwordx4 v[248:251], v2, s[48:51], s56 offen nt
  s_add_u32 s56, s56, 4096
  s_waitcnt vmcnt(5)
  buffer_load_dwordx4 v[252:255], v2, s[48:51], s56 offen nt
  s_add_u32 s56, s56, 4096
  s_waitcnt vmcnt(5)
  s_add_u32 m0, s59, 0
  s_nop 0
  buffer_load_dwordx4 v2, s[48:51], s56 offen nt lds
  s_add_u32 s56, s56, 4096
  s_waitcnt vmcnt(5)
  s_add_u32 m0, s59, 1024
  s_nop 0
  buffer_load_dwordx4 v2, s[48:51], s56 offen nt lds
  s_add_u32 s56, s56, 4096
  s_waitcnt vmcnt(5)
  s_add_u32 m0, s59, 2048
  s_nop 0
  buffer_load_dwordx4 v2, s[48:51], s56 offen nt lds
  s_add_u32 s56, s56, 4096
  s_waitcnt vmcnt(5)
  s_add_u32 m0, s59, 3072
  s_nop 0
  buffer_load_dwordx4 v2, s[48:51], s56 offen nt lds
  s_add_u32 s56, s56, 4096
  s_waitcnt vmcnt(5)
  s_add_u32 m0, s59, 4096
  s_nop 0
  buffer_load_dwordx4 v2, s[48:51], s56 offen nt lds
  s_add_u32 s56, s56, 4096
  s_waitcnt vmcnt(5)
  s_add_u32 m0, s59, 5120
  s_nop 0
  buffer_load_dwordx4 v2, s[48:51], s56 offen nt lds
  s_add_u32 s56, s56, 4096
  s_waitcnt vmcnt(5)
  s_add_u32 m0, s59, 6144
  s_nop 0
  buffer_load_dwordx4 v2, s[48:51], s56 offen nt lds
  s_add_u32 s56, s56, 4096
  s_waitcnt vmcnt(5)
  s_add_u32 m0, s59, 7168
  s_nop 0
  buffer_load_dwordx4 v2, s[48:51], s56 offen nt lds
  s_add_u32 s56, s56, 4096
  s_waitcnt vmcnt(5)
  s_add_u32 m0, s59, 8192
  s_nop 0
  buffer_load_dwordx4 v2, s[48:51], s56 offen nt lds
  s_add_u32 s56, s56, 4096
  s_waitcnt vmcnt(5)
  s_add_u32 m0, s59, 9216
  s_nop 0
  buffer_load_dwordx4 v2, s[48:51], s56 offen nt lds
  s_add_u32 s56, s56, 4096
  s_waitcnt vmcnt(5)
  s_add_u32 m0, s59, 10240
  s_nop 0
  buffer_load_dwordx4 v2, s[48:51], s56 offen nt lds
  s_add_u32 s56, s56, 4096
  s_waitcnt vmcnt(5)
  s_add_u32 m0, s59, 11264
  s_nop 0
  buffer_load_dwordx4 v2, s[48:51], s56 offen nt lds
  s_add_u32 s56, s56, 4096
  s_waitcnt vmcnt(5)
  s_add_u32 m0, s59, 12288
  s_nop 0
  buffer_load_dwordx4 v2, s[48:51], s56 offen nt lds
  s_add_u32 s56, s56, 4096
  s_waitcnt vmcnt(5)
  s_add_u32 m0, s59, 13312
  s_nop 0
  buffer_load_dwordx4 v2, s[48:51], s56 offen nt lds
  s_add_u32 s56, s56, 4096
  s_waitcnt vmcnt(5)
  s_add_u32 m0, s59, 14336
  s_nop 0
  buffer_load_dwordx4 v2, s[48:51], s56 offen nt lds
  s_add_u32 s56, s56, 4096
  s_waitcnt vmcnt(5)
  s_add_u32 m0, s59, 15360
  s_nop 0
  buffer_load_dwordx4 v2, s[48:51], s56 offen nt lds
  s_add_u32 s56, s56, 4096
  s_waitcnt vmcnt(5)
  s_add_u32 m0, s59, 16384
  s_nop 0
  buffer_load_dwordx4 v2, s[48:51], s56 offen nt lds
  s_add_u32 s56, s56, 4096
  s_waitcnt vmcnt(5)
  s_add_u32 m0, s59, 17408
  s_nop 0
  buffer_load_dwordx4 v2, s[48:51], s56 offen nt lds
  s_add_u32 s56, s56, 4096
  s_waitcnt vmcnt(5)
  s_add_u32 m0, s59, 18432
  s_nop 0
  buffer_load_dwordx4 v2, s[48:51], s56 offen nt lds
  s_add_u32 s56, s56, 4096
  s_waitcnt lgkmcnt(0)
  s_add_u32 s33, s32, 1
  s_mul_i32 s33, s33, 0x9E3779B1
  buffer_load_dwordx4 v[8:11], v5, s[44:47], s66 offen sc1
  buffer_load_dwordx4 v[12:15], v5, s[44:47], s66 offen offset:16 sc1
  s_waitcnt vmcnt(5)
  s_add_u32 m0, s59, 19456
  s_nop 0
  buffer_load_dwordx4 v2, s[48:51], s56 offen nt lds
  s_add_u32 s56, s56, 4096
  s_waitcnt vmcnt(5)
  s_add_u32 m0, s59, 20480
  s_nop 0
  buffer_load_dwordx4 v2, s[48:51], s56 offen nt lds
  s_add_u32 s56, s56, 4096
  s_waitcnt vmcnt(5)
  s_add_u32 m0, s59, 21504
  s_nop 0
  buffer_load_dwordx4 v2, s[48:51], s56 offen nt lds
  s_add_u32 s56, s56, 4096
  s_waitcnt vmcnt(5)
  s_add_u32 m0, s59, 22528
  s_nop 0
  buffer_load_dwordx4 v2, s[48:51], s56 offen nt lds
  s_add_u32 s56, s56, 4096
  s_waitcnt vmcnt(5)
  s_add_u32 m0, s59, 23552
  s_nop 0
  buffer_load_dwordx4 v2, s[48:51], s56 offen nt lds
  s_add_u32 s56, s56, 4096
  s_waitcnt vmcnt(5)
  s_add_u32 m0, s59, 24576
  s_nop 0
  buffer_load_dwordx4 v2, s[48:51], s56 offen nt lds
  s_add_u32 s56, s56, 4096
  s_mov_b32 s71, 262144
  s_branch L_qc_4
L_q_2:
  buffer_load_dwordx4 v[8:11], v5, s[44:47], s66 offen sc1
  buffer_load_dwordx4 v[12:15], v5, s[44:47], s66 offen offset:16 sc1
  s_waitcnt vmcnt(0)
L_qc_4:
  v_xor_b32 v18, s33, v9
  v_xor_b32 v19, s33, v11
  v_or_b32 v18, v18, v19
  v_xor_b32 v19, s33, v13
  v_xor_b32 v20, s33, v15
  v_or3_b32 v18, v18, v19, v20
  v_cmp_ne_u32 vcc, 0, v18
  s_cbranch_vccz L_qd_3
  s_sub_u32 s71, s71, 1
  s_cmp_eq_u32 s71, 0
  s_cbranch_scc1 L_qd_3
  s_sleep 4
  s_branch L_q_2
L_qd_3:
  v_dot2_f32_bf16 v20, v64, v8, 0
  v_dot2_f32_bf16 v20, v65, v10, v20
  v_dot2_f32_bf16 v20, v66, v12, v20
  v_dot2_f32_bf16 v20, v67, v14, v20
  v_dot2_f32_bf16 v21, v68, v8, 0
  v_dot2_f32_bf16 v21, v69, v10, v21
  v_dot2_f32_bf16 v21, v70, v12, v21
  v_dot2_f32_bf16 v21, v71, v14, v21
  s_nop 2
  v_permlane16_swap_b32 v20, v21
  v_add_f32 v22, v20, v21
  v_dot2_f32_bf16 v20, v72, v8, 0
  v_dot2_f32_bf16 v20, v73, v10, v20
  v_dot2_f32_bf16 v20, v74, v12, v20
  v_dot2_f32_bf16 v20, v75, v14, v20
  v_dot2_f32_bf16 v21, v76, v8, 0
  v_dot2_f32_bf16 v21, v77, v10, v21
  v_dot2_f32_bf16 v21, v78, v12, v21
  v_dot2_f32_bf16 v21, v79, v14, v21
  s_nop 2
  v_permlane16_swap_b32 v20, v21
  v_add_f32 v23, v20, v21
  v_add_f32_dpp v24, v22, v22 row_ror:8 row_mask:0xf bank_mask:0x3
  s_nop 1
  v_add_f32_dpp v24, v23, v23 row_ror:8 row_mask:0xf bank_mask:0xc
  v_dot2_f32_bf16 v20, v80, v8, 0
  v_dot2_f32_bf16 v20, v81, v10, v20
  v_dot2_f32_bf16 v20, v82, v12, v20
  v_dot2_f32_bf16 v20, v83, v14, v20
  v_dot2_f32_bf16 v21, v84, v8, 0
  v_dot2_f32_bf16 v21, v85, v10, v21
  v_dot2_f32_bf16 v21, v86, v12, v21
  v_dot2_f32_bf16 v21, v87, v14, v21
  s_nop 2
  v_permlane16_swap_b32 v20, v21
  v_add_f32 v22, v20, v21
  v_dot2_f32_bf16 v20, v88, v8, 0
  v_dot2_f32_bf16 v20, v89, v10, v20
  v_dot2_f32_bf16 v20, v90, v12, v20
  v_dot2_f32_bf16 v20, v91, v14, v20
  v_dot2_f32_bf16 v21, v92, v8, 0
  v_dot2_f32_bf16 v21, v93, v10, v21
  v_dot2_f32_bf16 v21, v94, v12, v21
  v_dot2_f32_bf16 v21, v95, v14, v21
  s_nop 2
  v_permlane16_swap_b32 v20, v21
  v_add_f32 v23, v20, v21
  v_add_f32_dpp v25, v22, v22 row_ror:8 row_mask:0xf bank_mask:0x3
  s_nop 1
  v_add_f32_dpp v25, v23, v23 row_ror:8 row_mask:0xf bank_mask:0xc
  v_add_f32_dpp v26, v24, v24 row_shl:4 row_mask:0xf bank_mask:0x5
  s_nop 1
  v_add_f32_dpp v26, v25, v25 row_shr:4 row_mask:0xf bank_mask:0xa
  v_dot2_f32_bf16 v20, v96, v8, 0
  v_dot2_f32_bf16 v20, v97, v10, v20
  v_dot2_f32_bf16 v20, v98, v12, v20
  v_dot2_f32_bf16 v20, v99, v14, v20
  v_dot2_f32_bf16 v21, v100, v8, 0
  v_dot2_f32_bf16 v21, v101, v10, v21
  v_dot2_f32_bf16 v21, v102, v12, v21
  v_dot2_f32_bf16 v21, v103, v14, v21
  s_nop 2
  v_permlane16_swap_b32 v20, v21
  v_add_f32 v22, v20, v21
  v_dot2_f32_bf16 v20, v104, v8, 0
  v_dot2_f32_bf16 v20, v105, v10, v20
  v_dot2_f32_bf16 v20, v106, v12, v20
  v_dot2_f32_bf16 v20, v107, v14, v20
  v_dot2_f32_bf16 v21, v108, v8, 0
  v_dot2_f32_bf16 v21, v109, v10, v21
  v_dot2_f32_bf16 v21, v110, v12, v21
  v_dot2_f32_bf16 v21, v111, v14, v21
  s_nop 2
  v_permlane16_swap_b32 v20, v21
  v_add_f32 v23, v20, v21
  v_add_f32_dpp v24, v22, v22 row_ror:8 row_mask:0xf bank_mask:0x3
  s_nop 1
  v_add_f32_dpp v24, v23, v23 row_ror:8 row_mask:0xf bank_mask:0xc
  s_waitcnt vmcnt(5)
  buffer_load_dwordx4 v[64:67], v2, s[48:51], s56 offen nt
  s_add_u32 s56, s56, 4096
  v_dot2_f32_bf16 v20, v112, v8, 0
  v_dot2_f32_bf16 v20, v113, v10, v20
  v_dot2_f32_bf16 v20, v114, v12, v20
  v_dot2_f32_bf16 v20, v115, v14, v20
  v_dot2_f32_bf16 v21, v116, v8, 0
  v_dot2_f32_bf16 v21, v117, v10, v21
  v_dot2_f32_bf16 v21, v118, v12, v21
  v_dot2_f32_bf16 v21, v119, v14, v21
  s_nop 2
  v_permlane16_swap_b32 v20, v21
  v_add_f32 v22, v20, v21
  v_dot2_f32_bf16 v20, v120, v8, 0
  v_dot2_f32_bf16 v20, v121, v10, v20
  v_dot2_f32_bf16 v20, v122, v12, v20
  v_dot2_f32_bf16 v20, v123, v14, v20
  v_dot2_f32_bf16 v21, v124, v8, 0
  v_dot2_f32_bf16 v21, v125, v10, v21
  v_dot2_f32_bf16 v21, v126, v12, v21
  v_dot2_f32_bf16 v21, v127, v14, v21
  s_nop 2
  v_permlane16_swap_b32 v20, v21
  v_add_f32 v23, v20, v21
  v_add_f32_dpp v25, v22, v22 row_ror:8 row_mask:0xf bank_mask:0x3
  s_nop 1
  v_add_f32_dpp v25, v23, v23 row_ror:8 row_mask:0xf bank_mask:0xc
  v_add_f32_dpp v27, v24, v24 row_shl:4 row_mask:0xf bank_mask:0x5
  s_nop 1
  v_add_f32_dpp v27, v25, v25 row_shr:4 row_mask:0xf bank_mask:0xa
  v_add_f32_dpp v30, v26, v26 quad_perm:[2,3,0,1] row_mask:0xf bank_mask:0xf
  s_nop 0
  v_add_f32_dpp v31, v27, v27 quad_perm:[2,3,0,1] row_mask:0xf bank_mask:0xf
  v_cndmask_b32 v28, v30, v31, s[60:61]
  v_dot2_f32_bf16 v20, v128, v8, 0
  v_dot2_f32_bf16 v20, v129, v10, v20
  v_dot2_f32_bf16 v20, v130, v12, v20
  v_dot2_f32_bf16 v20, v131, v14, v20
  v_dot2_f32_bf16 v21, v132, v8, 0
  v_dot2_f32_bf16 v21, v133, v10, v21
  v_dot2_f32_bf16 v21, v134, v12, v21
  v_dot2_f32_bf16 v21, v135, v14, v21
  s_nop 2
  v_permlane16_swap_b32 v20, v21
  v_add_f32 v22, v20, v21
  v_dot2_f32_bf16 v20, v136, v8, 0
  v_dot2_f32_bf16 v20, v137, v10, v20
  v_dot2_f32_bf16 v20, v138, v12, v20
  v_dot2_f32_bf16 v20, v139, v14, v20
  v_dot2_f32_bf16 v21, v140, v8, 0
  v_dot2_f32_bf16 v21, v141, v10, v21
  v_dot2_f32_bf16 v21, v142, v12, v21
  v_dot2_f32_bf16 v21, v143, v14, v21
  s_nop 2
  v_permlane16_swap_b32 v20, v21
  v_add_f32 v23, v20, v21
  v_add_f32_dpp v24, v22, v22 row_ror:8 row_mask:0xf bank_mask:0x3
  s_nop 1
  v_add_f32_dpp v24, v23, v23 row_ror:8 row_mask:0xf bank_mask:0xc
  v_dot2_f32_bf16 v20, v144, v8, 0
  v_dot2_f32_bf16 v20, v145, v10, v20
  v_dot2_f32_bf16 v20, v146, v12, v20
  v_dot2_f32_bf16 v20, v147, v14, v20
  v_dot2_f32_bf16 v21, v148, v8, 0
  v_dot2_f32_bf16 v21, v149, v10, v21
  v_dot2_f32_bf16 v21, v150, v12, v21
  v_dot2_f32_bf16 v21, v151, v14, v21
  s_nop 2
  v_permlane16_swap_b32 v20, v21
  v_add_f32 v22, v20, v21
  v_dot2_f32_bf16 v20, v152, v8, 0
  v_dot2_f32_bf16 v20, v153, v10, v20
  v_dot2_f32_bf16 v20, v154, v12, v20
  v_dot2_f32_bf16 v20, v155, v14, v20
  v_dot2_f32_bf16 v21, v156, v8, 0
  v_dot2_f32_bf16 v21, v157, v10, v21
  v_dot2_f32_bf16 v21, v158, v12, v21
  v_dot2_f32_bf16 v21, v159, v14, v21
  s_nop 2
  v_permlane16_swap_b32 v20, v21
  v_add_f32 v23, v20, v21
  v_add_f32_dpp v25, v22, v22 row_ror:8 row_mask:0xf bank_mask:0x3
  s_nop 1
  v_add_f32_dpp v25, v23, v23 row_ror:8 row_mask:0xf bank_mask:0xc
  v_add_f32_dpp v26, v24, v24 row_shl:4 row_mask:0xf bank_mask:0x5
  s_nop 1
  v_add_f32_dpp v26, v25, v25 row_shr:4 row_mask:0xf bank_mask:0xa
  s_waitcnt vmcnt(5)
  buffer_load_dwordx4 v[68:71], v2, s[48:51], s56 offen nt
  s_add_u32 s56, s56, 4096
  v_dot2_f32_bf16 v20, v160, v8, 0
  v_dot2_f32_bf16 v20, v161, v10, v20
  v_dot2_f32_bf16 v20, v162, v12, v20
  v_dot2_f32_bf16 v20, v163, v14, v20
  v_dot2_f32_bf16 v21, v164, v8, 0
  v_dot2_f32_bf16 v21, v165, v10, v21
  v_dot2_f32_bf16 v21, v166, v12, v21
  v_dot2_f32_bf16 v21, v167, v14, v21
  s_nop 2
  v_permlane16_swap_b32 v20, v21
  v_add_f32 v22, v20, v21
  v_dot2_f32_bf16 v20, v168, v8, 0
  v_dot2_f32_bf16 v20, v169, v10, v20
  v_dot2_f32_bf16 v20, v170, v12, v20
  v_dot2_f32_bf16 v20, v171, v14, v20
  v_dot2_f32_bf16 v21, v172, v8, 0
  v_dot2_f32_bf16 v21, v173, v10, v21
  v_dot2_f32_bf16 v21, v174, v12, v21
  v_dot2_f32_bf16 v21, v175, v14, v21
  s_nop 2
  v_permlane16_swap_b32 v20, v21
  v_add_f32 v23, v20, v21
  v_add_f32_dpp v24, v22, v22 row_ror:8 row_mask:0xf bank_mask:0x3
  s_nop 1
  v_add_f32_dpp v24, v23, v23 row_ror:8 row_mask:0xf bank_mask:0xc
  v_dot2_f32_bf16 v20, v176, v8, 0
  v_dot2_f32_bf16 v20, v177, v10, v20
  v_dot2_f32_bf16 v20, v178, v12, v20
  v_dot2_f32_bf16 v20, v179, v14, v20
  v_dot2_f32_bf16 v21, v180, v8, 0
  v_dot2_f32_bf16 v21, v181, v10, v21
  v_dot2_f32_bf16 v21, v182, v12, v21
  v_dot2_f32_bf16 v21, v183, v14, v21
  s_nop 2
  v_permlane16_swap_b32 v20, v21
  v_add_f32 v22, v20, v21
  v_dot2_f32_bf16 v20, v184, v8, 0
  v_dot2_f32_bf16 v20, v185, v10, v20
  v_dot2_f32_bf16 v20, v186, v12, v20
  v_dot2_f32_bf16 v20, v187, v14, v20
  v_dot2_f32_bf16 v21, v188, v8, 0
  v_dot2_f32_bf16 v21, v189, v10, v21
  v_dot2_f32_bf16 v21, v190, v12, v21
  v_dot2_f32_bf16 v21, v191, v14, v21
  s_nop 2
  v_permlane16_swap_b32 v20, v21
  v_add_f32 v23, v20, v21
  v_add_f32_dpp v25, v22, v22 row_ror:8 row_mask:0xf bank_mask:0x3
  s_nop 1
  v_add_f32_dpp v25, v23, v23 row_ror:8 row_mask:0xf bank_mask:0xc
  v_add_f32_dpp v27, v24, v24 row_shl:4 row_mask:0xf bank_mask:0x5
  s_nop 1
  v_add_f32_dpp v27, v25, v25 row_shr:4 row_mask:0xf bank_mask:0xa
  v_add_f32_dpp v30, v26, v26 quad_perm:[2,3,0,1] row_mask:0xf bank_mask:0xf
  s_nop 0
  v_add_f32_dpp v31, v27, v27 quad_perm:[2,3,0,1] row_mask:0xf bank_mask:0xf
  v_cndmask_b32 v29, v30, v31, s[60:61]
  v_add_f32_dpp v30, v28, v28 quad_perm:[1,0,3,2] row_mask:0xf bank_mask:0xf
  s_nop 0
  v_add_f32_dpp v31, v29, v29 quad_perm:[1,0,3,2] row_mask:0xf bank_mask:0xf
  v_cndmask_b32 v32, v30, v31, s[62:63]
  ds_write_b32 v16, v32 offset:15744
  v_dot2_f32_bf16 v20, v192, v8, 0
  v_dot2_f32_bf16 v20, v193, v10, v20
  v_dot2_f32_bf16 v20, v194, v12, v20
  v_dot2_f32_bf16 v20, v195, v14, v20
  v_dot2_f32_bf16 v21, v196, v8, 0
  v_dot2_f32_bf16 v21, v197, v10, v21
  v_dot2_f32_bf16 v21, v198, v12, v21
  v_dot2_f32_bf16 v21, v199, v14, v21
  s_nop 2
  v_permlane16_swap_b32 v20, v21
  v_add_f32 v22, v20, v21
  v_dot2_f32_bf16 v20, v200, v8, 0
  v_dot2_f32_bf16 v20, v201, v10, v20
  v_dot2_f32_bf16 v20, v202, v12, v20
  v_dot2_f32_bf16 v20, v203, v14, v20
  v_dot2_f32_bf16 v21, v204, v8, 0
  v_dot2_f32_bf16 v21, v205, v10, v21
  v_dot2_f32_bf16 v21, v206, v12, v21
  v_dot2_f32_bf16 v21, v207, v14, v21
  s_nop 2
  v_permlane16_swap_b32 v20, v21
  v_add_f32 v23, v20, v21
  v_add_f32_dpp v24, v22, v22 row_ror:8 row_mask:0xf bank_mask:0x3
  s_nop 1
  v_add_f32_dpp v24, v23, v23 row_ror:8 row_mask:0xf bank_mask:0xc
  s_waitcnt vmcnt(5)
  buffer_load_dwordx4 v[72:75], v2, s[48:51], s56 offen nt
  s_add_u32 s56, s56, 4096
  v_dot2_f32_bf16 v20, v208, v8, 0
  v_dot2_f32_bf16 v20, v209, v10, v20
  v_dot2_f32_bf16 v20, v210, v12, v20
  v_dot2_f32_bf16 v20, v211, v14, v20
  v_dot2_f32_bf16 v21, v212, v8, 0
  v_dot2_f32_bf16 v21, v213, v10, v21
  v_dot2_f32_bf16 v21, v214, v12, v21
  v_dot2_f32_bf16 v21, v215, v14, v21
  s_nop 2
  v_permlane16_swap_b32 v20, v21
  v_add_f32 v22, v20, v21
  v_dot2_f32_bf16 v20, v216, v8, 0
  v_dot2_f32_bf16 v20, v217, v10, v20
  v_dot2_f32_bf16 v20, v218, v12, v20
  v_dot2_f32_bf16 v20, v219, v14, v20
  v_dot2_f32_bf16 v21, v220, v8, 0
  v_dot2_f32_bf16 v21, v221, v10, v21
  v_dot2_f32_bf16 v21, v222, v12, v21
  v_dot2_f32_bf16 v21, v223, v14, v21
  s_nop 2
  v_permlane16_swap_b32 v20, v21
  v_add_f32 v23, v20, v21
  v_add_f32_dpp v25, v22, v22 row_ror:8 row_mask:0xf bank_mask:0x3
  s_nop 1
  v_add_f32_dpp v25, v23, v23 row_ror:8 row_mask:0xf bank_mask:0xc
  v_add_f32_dpp v26, v24, v24 row_shl:4 row_mask:0xf bank_mask:0x5
  s_nop 1
  v_add_f32_dpp v26, v25, v25 row_shr:4 row_mask:0xf bank_mask:0xa
  v_dot2_f32_bf16 v20, v224, v8, 0
  v_dot2_f32_bf16 v20, v225, v10, v20
  v_dot2_f32_bf16 v20, v226, v12, v20
  v_dot2_f32_bf16 v20, v227, v14, v20
  v_dot2_f32_bf16 v21, v228, v8, 0
  v_dot2_f32_bf16 v21, v229, v10, v21
  v_dot2_f32_bf16 v21, v230, v12, v21
  v_dot2_f32_bf16 v21, v231, v14, v21
  s_nop 2
  v_permlane16_swap_b32 v20, v21
  v_add_f32 v22, v20, v21
  v_dot2_f32_bf16 v20, v232, v8, 0
  v_dot2_f32_bf16 v20, v233, v10, v20
  v_dot2_f32_bf16 v20, v234, v12, v20
  v_dot2_f32_bf16 v20, v235, v14, v20
  v_dot2_f32_bf16 v21, v236, v8, 0
  v_dot2_f32_bf16 v21, v237, v10, v21
  v_dot2_f32_bf16 v21, v238, v12, v21
  v_dot2_f32_bf16 v21, v239, v14, v21
  s_nop 2
  v_permlane16_swap_b32 v20, v21
  v_add_f32 v23, v20, v21
  v_add_f32_dpp v24, v22, v22 row_ror:8 row_mask:0xf bank_mask:0x3
  s_nop 1
  v_add_f32_dpp v24, v23, v23 row_ror:8 row_mask:0xf bank_mask:0xc
  v_dot2_f32_bf16 v20, v240, v8, 0
  v_dot2_f32_bf16 v20, v241, v10, v20
  v_dot2_f32_bf16 v20, v242, v12, v20
  v_dot2_f32_bf16 v20, v243, v14, v20
  v_dot2_f32_bf16 v21, v244, v8, 0
  v_dot2_f32_bf16 v21, v245, v10, v21
  v_dot2_f32_bf16 v21, v246, v12, v21
  v_dot2_f32_bf16 v21, v247, v14, v21
  s_nop 2
  v_permlane16_swap_b32 v20, v21
  v_add_f32 v22, v20, v21
  v_dot2_f32_bf16 v20, v248, v8, 0
  v_dot2_f32_bf16 v20, v249, v10, v20
  v_dot2_f32_bf16 v20, v250, v12, v20
  v_dot2_f32_bf16 v20, v251, v14, v20
  ds_read_b128 v[56:59], v33 offset:0
  v_dot2_f32_bf16 v21, v252, v8, 0
  v_dot2_f32_bf16 v21, v253, v10, v21
  v_dot2_f32_bf16 v21, v254, v12, v21
  v_dot2_f32_bf16 v21, v255, v14, v21
  s_nop 2
  v_permlane16_swap_b32 v20, v21
  v_add_f32 v23, v20, v21
  v_add_f32_dpp v25, v22, v22 row_ror:8 row_mask:0xf bank_mask:0x3
  s_nop 1
  v_add_f32_dpp v25, v23, v23 row_ror:8 row_mask:0xf bank_mask:0xc
  v_add_f32_dpp v27, v24, v24 row_shl:4 row_mask:0xf bank_mask:0x5
  s_nop 1
  v_add_f32_dpp v27, v25, v25 row_shr:4 row_mask:0xf bank_mask:0xa
  v_add_f32_dpp v30, v26, v26 quad_perm:[2,3,0,1] row_mask:0xf bank_mask:0xf
  s_nop 0
  v_add_f32_dpp v31, v27, v27 quad_perm:[2,3,0,1] row_mask:0xf bank_mask:0xf
  v_cndmask_b32 v28, v30, v31, s[60:61]
  s_waitcnt lgkmcnt(0)
  ds_read_b128 v[60:63], v33 offset:1024
  v_dot2_f32_bf16 v20, v56, v8, 0
  v_dot2_f32_bf16 v20, v57, v10, v20
  v_dot2_f32_bf16 v20, v58, v12, v20
  v_dot2_f32_bf16 v20, v59, v14, v20
  s_waitcnt vmcnt(5)
  buffer_load_dwordx4 v[76:79], v2, s[48:51], s56 offen nt
  s_add_u32 s56, s56, 4096
  s_waitcnt lgkmcnt(0)
  ds_read_b128 v[56:59], v33 offset:2048
  v_dot2_f32_bf16 v21, v60, v8, 0
  v_dot2_f32_bf16 v21, v61, v10, v21
  v_dot2_f32_bf16 v21, v62, v12, v21
  v_dot2_f32_bf16 v21, v63, v14, v21
  s_nop 2
  v_permlane16_swap_b32 v20, v21
  v_add_f32 v22, v20, v21
  s_waitcnt lgkmcnt(0)
  ds_read_b128 v[60:63], v33 offset:3072
  v_dot2_f32_bf16 v20, v56, v8, 0
  v_dot2_f32_bf16 v20, v57, v10, v20
  v_dot2_f32_bf16 v20, v58, v12, v20
  v_dot2_f32_bf16 v20, v59, v14, v20
  s_waitcnt lgkmcnt(0)
  ds_read_b128 v[56:59], v33 offset:4096
  v_dot2_f32_bf16 v21, v60, v8, 0
  v_dot2_f32_bf16 v21, v61, v10, v21
  v_dot2_f32_bf16 v21, v62, v12, v21
  v_dot2_f32_bf16 v21, v63, v14, v21
  s_nop 2
  v_permlane16_swap_b32 v20, v21
  v_add_f32 v23, v20, v21
  v_add_f32_dpp v24, v22, v22 row_ror:8 row_mask:0xf bank_mask:0x3
  s_nop 1
  v_add_f32_dpp v24, v23, v23 row_ror:8 row_mask:0xf bank_mask:0xc
  s_waitcnt lgkmcnt(0)
  ds_read_b128 v[60:63], v33 offset:5120
  v_dot2_f32_bf16 v20, v56, v8, 0
  v_dot2_f32_bf16 v20, v57, v10, v20
  v_dot2_f32_bf16 v20, v58, v12, v20
  v_dot2_f32_bf16 v20, v59, v14, v20
  s_waitcnt lgkmcnt(0)
  ds_read_b128 v[56:59], v33 offset:6144
  v_dot2_f32_bf16 v21, v60, v8, 0
  v_dot2_f32_bf16 v21, v61, v10, v21
  v_dot2_f32_bf16 v21, v62, v12, v21
  v_dot2_f32_bf16 v21, v63, v14, v21
  s_nop 2
  v_permlane16_swap_b32 v20, v21
  v_add_f32 v22, v20, v21
  s_waitcnt lgkmcnt(0)
  ds_read_b128 v[60:63], v33 offset:7168
  v_dot2_f32_bf16 v20, v56, v8, 0
  v_dot2_f32_bf16 v20, v57, v10, v20
  v_dot2_f32_bf16 v20, v58, v12, v20
  v_dot2_f32_bf16 v20, v59, v14, v20
  s_waitcnt lgkmcnt(0)
  ds_read_b128 v[56:59], v33 offset:8192
  v_dot2_f32_bf16 v21, v60, v8, 0
  v_dot2_f32_bf16 v21, v61, v10, v21
  v_dot2_f32_bf16 v21, v62, v12, v21
  v_dot2_f32_bf16 v21, v63, v14, v21
  s_nop 2
  v_permlane16_swap_b32 v20, v21
  v_add_f32 v23, v20, v21
  v_add_f32_dpp v25, v22, v22 row_ror:8 row_mask:0xf bank_mask:0x3
  s_nop 1
  v_add_f32_dpp v25, v23, v23 row_ror:8 row_mask:0xf bank_mask:0xc
  v_add_f32_dpp v26, v24, v24 row_shl:4 row_mask:0xf bank_mask:0x5
  s_nop 1
  v_add_f32_dpp v26, v25, v25 row_shr:4 row_mask:0xf bank_mask:0xa
  s_waitcnt lgkmcnt(0)
  ds_read_b128 v[60:63], v33 offset:9216
  v_dot2_f32_bf16 v20, v56, v8, 0
  v_dot2_f32_bf16 v20, v57, v10, v20
  v_dot2_f32_bf16 v20, v58, v12, v20
  v_dot2_f32_bf16 v20, v59, v14, v20
  s_waitcnt lgkmcnt(0)
  ds_read_b128 v[56:59], v33 offset:10240
  v_dot2_f32_bf16 v21, v60, v8, 0
  v_dot2_f32_bf16 v21, v61, v10, v21
  v_dot2_f32_bf16 v21, v62, v12, v21
  v_dot2_f32_bf16 v21, v63, v14, v21
  s_nop 2
  v_permlane16_swap_b32 v20, v21
  v_add_f32 v22, v20, v21
  s_waitcnt lgkmcnt(0)
  ds_read_b128 v[60:63], v33 offset:11264
  v_dot2_f32_bf16 v20, v56, v8, 0
  v_dot2_f32_bf16 v20, v57, v10, v20
  v_dot2_f32_bf16 v20, v58, v12, v20
  v_dot2_f32_bf16 v20, v59, v14, v20
  s_waitcnt lgkmcnt(0)
  ds_read_b128 v[56:59], v33 offset:12288
  v_dot2_f32_bf16 v21, v60, v8, 0
  v_dot2_f32_bf16 v21, v61, v10, v21
  v_dot2_f32_bf16 v21, v62, v12, v21
  v_dot2_f32_bf16 v21, v63, v14, v21
  s_nop 2
  v_permlane16_swap_b32 v20, v21
  v_add_f32 v23, v20, v21
  v_add_f32_dpp v24, v22, v22 row_ror:8 row_mask:0xf bank_mask:0x3
  s_nop 1
  v_add_f32_dpp v24, v23, v23 row_ror:8 row_mask:0xf bank_mask:0xc
  s_waitcnt lgkmcnt(0)
  ds_read_b128 v[60:63], v33 offset:13312
  v_dot2_f32_bf16 v20, v56, v8, 0
  v_dot2_f32_bf16 v20, v57, v10, v20
  v_dot2_f32_bf16 v20, v58, v12, v20
  v_dot2_f32_bf16 v20, v59, v14, v20
  s_waitcnt vmcnt(5)
  buffer_load_dwordx4 v[80:83], v2, s[48:51], s56 offen nt
  s_add_u32 s56, s56, 4096
  s_waitcnt lgkmcnt(0)
  ds_read_b128 v[56:59], v33 offset:14336
  v_dot2_f32_bf16 v21, v60, v8, 0
  v_dot2_f32_bf16 v21, v61, v10, v21
  v_dot2_f32_bf16 v21, v62, v12, v21
  v_dot2_f32_bf16 v21, v63, v14, v21
  s_nop 2
  v_permlane16_swap_b32 v20, v21
  v_add_f32 v22, v20, v21
  s_waitcnt lgkmcnt(0)
  ds_read_b128 v[60:63], v33 offset:15360
  v_dot2_f32_bf16 v20, v56, v8, 0
  v_dot2_f32_bf16 v20, v57, v10, v20
  v_dot2_f32_bf16 v20, v58, v12, v20
  v_dot2_f32_bf16 v20, v59, v14, v20
  s_waitcnt lgkmcnt(0)
  ds_read_b128 v[56:59], v33 offset:16384
  v_dot2_f32_bf16 v21, v60, v8, 0
  v_dot2_f32_bf16 v21, v61, v10, v21
  v_dot2_f32_bf16 v21, v62, v12, v21
  v_dot2_f32_bf16 v21, v63, v14, v21
  s_nop 2
  v_permlane16_swap_b32 v20, v21
  v_add_f32 v23, v20, v21
  v_add_f32_dpp v25, v22, v22 row_ror:8 row_mask:0xf bank_mask:0x3
  s_nop 1
  v_add_f32_dpp v25, v23, v23 row_ror:8 row_mask:0xf bank_mask:0xc
  v_add_f32_dpp v27, v24, v24 row_shl:4 row_mask:0xf bank_mask:0x5
  s_nop 1
  v_add_f32_dpp v27, v25, v25 row_shr:4 row_mask:0xf bank_mask:0xa
  v_add_f32_dpp v30, v26, v26 quad_perm:[2,3,0,1] row_mask:0xf bank_mask:0xf
  s_nop 0
  v_add_f32_dpp v31, v27, v27 quad_perm:[2,3,0,1] row_mask:0xf bank_mask:0xf
  v_cndmask_b32 v29, v30, v31, s[60:61]
  v_add_f32_dpp v30, v28, v28 quad_perm:[1,0,3,2] row_mask:0xf bank_mask:0xf
  s_nop 0
  v_add_f32_dpp v31, v29, v29 quad_perm:[1,0,3,2] row_mask:0xf bank_mask:0xf
  v_cndmask_b32 v32, v30, v31, s[62:63]
  ds_write_b32 v16, v32 offset:15760
  s_waitcnt lgkmcnt(0)
  ds_read_b128 v[60:63], v33 offset:17408
  v_dot2_f32_bf16 v20, v56, v8, 0
  v_dot2_f32_bf16 v20, v57, v10, v20
  v_dot2_f32_bf16 v20, v58, v12, v20
  v_dot2_f32_bf16 v20, v59, v14, v20
  s_waitcnt lgkmcnt(0)
  ds_read_b128 v[56:59], v33 offset:18432
  v_dot2_f32_bf16 v21, v60, v8, 0
  v_dot2_f32_bf16 v21, v61, v10, v21
  v_dot2_f32_bf16 v21, v62, v12, v21
  v_dot2_f32_bf16 v21, v63, v14, v21
  s_nop 2
  v_permlane16_swap_b32 v20, v21
  v_add_f32 v22, v20, v21
  s_waitcnt lgkmcnt(0)
  ds_read_b128 v[60:63], v33 offset:19456
  v_dot2_f32_bf16 v20, v56, v8, 0
  v_dot2_f32_bf16 v20, v57, v10, v20
  v_dot2_f32_bf16 v20, v58, v12, v20
  v_dot2_f32_bf16 v20, v59, v14, v20
  s_waitcnt lgkmcnt(0)
  ds_read_b128 v[56:59], v33 offset:20480
  v_dot2_f32_bf16 v21, v60, v8, 0
  v_dot2_f32_bf16 v21, v61, v10, v21
  v_dot2_f32_bf16 v21, v62, v12, v21
  v_dot2_f32_bf16 v21, v63, v14, v21
  s_nop 2
  v_permlane16_swap_b32 v20, v21
  v_add_f32 v23, v20, v21
  v_add_f32_dpp v24, v22, v22 row_ror:8 row_mask:0xf bank_mask:0x3
  s_nop 1
  v_add_f32_dpp v24, v23, v23 row_ror:8 row_mask:0xf bank_mask:0xc
  s_waitcnt lgkmcnt(0)
  ds_read_b128 v[60:63], v33 offset:21504
  v_dot2_f32_bf16 v20, v56, v8, 0
  v_dot2_f32_bf16 v20, v57, v10, v20
  v_dot2_f32_bf16 v20, v58, v12, v20
  v_dot2_f32_bf16 v20, v59, v14, v20
  s_waitcnt lgkmcnt(0)
  ds_read_b128 v[56:59], v33 offset:22528
  v_dot2_f32_bf16 v21, v60, v8, 0
  v_dot2_f32_bf16 v21, v61, v10, v21
  v_dot2_f32_bf16 v21, v62, v12, v21
  v_dot2_f32_bf16 v21, v63, v14, v21
  s_nop 2
  v_permlane16_swap_b32 v20, v21
  v_add_f32 v22, v20, v21
  s_waitcnt lgkmcnt(0)
  ds_read_b128 v[60:63], v33 offset:23552
  v_dot2_f32_bf16 v20, v56, v8, 0
  v_dot2_f32_bf16 v20, v57, v10, v20
  v_dot2_f32_bf16 v20, v58, v12, v20
  v_dot2_f32_bf16 v20, v59, v14, v20
  s_waitcnt lgkmcnt(0)
  s_waitcnt vmcnt(5)
  ds_read_b128 v[56:59], v33 offset:24576
  v_dot2_f32_bf16 v21, v60, v8, 0
  v_dot2_f32_bf16 v21, v61, v10, v21
  v_dot2_f32_bf16 v21, v62, v12, v21
  v_dot2_f32_bf16 v21, v63, v14, v21
  s_nop 2
  v_permlane16_swap_b32 v20, v21
  v_add_f32 v23, v20, v21
  v_add_f32_dpp v25, v22, v22 row_ror:8 row_mask:0xf bank_mask:0x3
  s_nop 1
  v_add_f32_dpp v25, v23, v23 row_ror:8 row_mask:0xf bank_mask:0xc
  v_add_f32_dpp v26, v24, v24 row_shl:4 row_mask:0xf bank_mask:0x5
  s_nop 1
  v_add_f32_dpp v26, v25, v25 row_shr:4 row_mask:0xf bank_mask:0xa
  s_waitcnt lgkmcnt(0)
  v_dot2_f32_bf16 v20, v56, v8, 0
  v_dot2_f32_bf16 v20, v57, v10, v20
  v_dot2_f32_bf16 v20, v58, v12, v20
  v_dot2_f32_bf16 v20, v59, v14, v20
  buffer_load_dwordx4 v[84:87], v2, s[48:51], s56 offen nt
  s_add_u32 s56, s56, 4096
  s_waitcnt vmcnt(5)
  buffer_load_dwordx4 v[88:91], v2, s[48:51], s56 offen nt
  s_add_u32 s56, s56, 4096
  v_dot2_f32_bf16 v21, v64, v8, 0
  v_dot2_f32_bf16 v21, v65, v10, v21
  v_dot2_f32_bf16 v21, v66, v12, v21
  v_dot2_f32_bf16 v21, v67, v14, v21
  s_nop 2
  v_permlane16_swap_b32 v20, v21
  v_add_f32 v22, v20, v21
  s_waitcnt vmcnt(5)
  buffer_load_dwordx4 v[92:95], v2, s[48:51], s56 offen nt
  s_add_u32 s56, s56, 4096
  v_dot2_f32_bf16 v20, v68, v8, 0
  v_dot2_f32_bf16 v20, v69, v10, v20
  v_dot2_f32_bf16 v20, v70, v12, v20
  v_dot2_f32_bf16 v20, v71, v14, v20
  s_waitcnt vmcnt(5)
  buffer_load_dwordx4 v[96:99], v2, s[48:51], s56 offen nt
  s_add_u32 s56, s56, 4096
  v_dot2_f32_bf16 v21, v72, v8, 0
  v_dot2_f32_bf16 v21, v73, v10, v21
  v_dot2_f32_bf16 v21, v74, v12, v21
  v_dot2_f32_bf16 v21, v75, v14, v21
  s_nop 2
  v_permlane16_swap_b32 v20, v21
  v_add_f32 v23, v20, v21
  v_add_f32_dpp v24, v22, v22 row_ror:8 row_mask:0xf bank_mask:0x3
  s_nop 1
  v_add_f32_dpp v24, v23, v23 row_ror:8 row_mask:0xf bank_mask:0xc
  s_waitcnt vmcnt(5)
  buffer_load_dwordx4 v[100:103], v2, s[48:51], s56 offen nt
  s_add_u32 s56, s56, 4096
  v_dot2_f32_bf16 v20, v76, v8, 0
  v_dot2_f32_bf16 v20, v77, v10, v20
  v_dot2_f32_bf16 v20, v78, v12, v20
  v_dot2_f32_bf16 v20, v79, v14, v20
  s_waitcnt vmcnt(5)
  buffer_load_dwordx4 v[104:107], v2, s[48:51], s56 offen nt
  s_add_u32 s56, s56, 4096
  v_dot2_f32_bf16 v21, v80, v8, 0
  v_dot2_f32_bf16 v21, v81, v10, v21
  v_dot2_f32_bf16 v21, v82, v12, v21
  v_dot2_f32_bf16 v21, v83, v14, v21
  s_nop 2
  v_permlane16_swap_b32 v20, v21
  v_add_f32 v22, v20, v21
  s_waitcnt vmcnt(5)
  buffer_load_dwordx4 v[108:111], v2, s[48:51], s56 offen nt
  s_add_u32 s56, s56, 4096
  v_dot2_f32_bf16 v20, v84, v8, 0
  v_dot2_f32_bf16 v20, v85, v10, v20
  v_dot2_f32_bf16 v20, v86, v12, v20
  v_dot2_f32_bf16 v20, v87, v14, v20
  s_waitcnt vmcnt(5)
  buffer_load_dwordx4 v[112:115], v2, s[48:51], s56 offen nt
  s_add_u32 s56, s56, 4096
  v_dot2_f32_bf16 v21, v88, v8, 0
  v_dot2_f32_bf16 v21, v89, v10, v21
  v_dot2_f32_bf16 v21, v90, v12, v21
  v_dot2_f32_bf16 v21, v91, v14, v21
  s_nop 2
  v_permlane16_swap_b32 v20, v21
  v_add_f32 v23, v20, v21
  v_add_f32_dpp v25, v22, v22 row_ror:8 row_mask:0xf bank_mask:0x3
  s_nop 1
  v_add_f32_dpp v25, v23, v23 row_ror:8 row_mask:0xf bank_mask:0xc
  v_add_f32_dpp v27, v24, v24 row_shl:4 row_mask:0xf bank_mask:0x5
  s_nop 1
  v_add_f32_dpp v27, v25, v25 row_shr:4 row_mask:0xf bank_mask:0xa
  v_add_f32_dpp v30, v26, v26 quad_perm:[2,3,0,1] row_mask:0xf bank_mask:0xf
  s_nop 0
  v_add_f32_dpp v31, v27, v27 quad_perm:[2,3,0,1] row_mask:0xf bank_mask:0xf
  v_cndmask_b32 v28, v30, v31, s[60:61]
  s_waitcnt vmcnt(5)
  buffer_load_dwordx4 v[116:119], v2, s[48:51], s56 offen nt
  s_add_u32 s56, s56, 4096
  v_dot2_f32_bf16 v20, v92, v8, 0
  v_dot2_f32_bf16 v20, v93, v10, v20
  v_dot2_f32_bf16 v20, v94, v12, v20
  v_dot2_f32_bf16 v20, v95, v14, v20
  s_waitcnt vmcnt(5)
  buffer_load_dwordx4 v[120:123], v2, s[48:51], s56 offen nt
  s_add_u32 s56, s56, 4096
  v_dot2_f32_bf16 v21, v96, v8, 0
  v_dot2_f32_bf16 v21, v97, v10, v21
  v_dot2_f32_bf16 v21, v98, v12, v21
  v_dot2_f32_bf16 v21, v99, v14, v21
  s_nop 2
  v_permlane16_swap_b32 v20, v21
  v_add_f32 v22, v20, v21
  s_waitcnt vmcnt(5)
  buffer_load_dwordx4 v[124:127], v2, s[48:51], s56 offen nt
  s_add_u32 s56, s56, 4096
  v_dot2_f32_bf16 v20, v100, v8, 0
  v_dot2_f32_bf16 v20, v101, v10, v20
  v_dot2_f32_bf16 v20, v102, v12, v20
  v_dot2_f32_bf16 v20, v103, v14, v20
  s_waitcnt vmcnt(5)
  buffer_load_dwordx4 v[64:67], v2, s[48:51], s56 offen nt
  s_add_u32 s56, s56, 4096
  v_dot2_f32_bf16 v21, v104, v8, 0
  v_dot2_f32_bf16 v21, v105, v10, v21
  v_dot2_f32_bf16 v21, v106, v12, v21
  v_dot2_f32_bf16 v21, v107, v14, v21
  s_nop 2
  v_permlane16_swap_b32 v20, v21
  v_add_f32 v23, v20, v21
  v_add_f32_dpp v24, v22, v22 row_ror:8 row_mask:0xf bank_mask:0x3
  s_nop 1
  v_add_f32_dpp v24, v23, v23 row_ror:8 row_mask:0xf bank_mask:0xc
  s_waitcnt vmcnt(5)
  buffer_load_dwordx4 v[68:71], v2, s[48:51], s56 offen nt
  s_add_u32 s56, s56, 4096
  v_dot2_f32_bf16 v20, v108, v8, 0
  v_dot2_f32_bf16 v20, v109, v10, v20
  v_dot2_f32_bf16 v20, v110, v12, v20
  v_dot2_f32_bf16 v20, v111, v14, v20
  s_waitcnt vmcnt(5)
  buffer_load_dwordx4 v[72:75], v2, s[48:51], s56 offen nt
  s_add_u32 s56, s56, 4096
  v_dot2_f32_bf16 v21, v112, v8, 0
  v_dot2_f32_bf16 v21, v113, v10, v21
  v_dot2_f32_bf16 v21, v114, v12, v21
  v_dot2_f32_bf16 v21, v115, v14, v21
  s_nop 2
  v_permlane16_swap_b32 v20, v21
  v_add_f32 v22, v20, v21
  s_waitcnt vmcnt(5)
  buffer_load_dwordx4 v[76:79], v2, s[48:51], s56 offen nt
  s_add_u32 s56, s56, 4096
  v_dot2_f32_bf16 v20, v116, v8, 0
  v_dot2_f32_bf16 v20, v117, v10, v20
  v_dot2_f32_bf16 v20, v118, v12, v20
  v_dot2_f32_bf16 v20, v119, v14, v20
  s_waitcnt vmcnt(5)
  buffer_load_dwordx4 v[80:83], v2, s[48:51], s56 offen nt
  s_add_u32 s56, s56, 4096
  v_dot2_f32_bf16 v21, v120, v8, 0
  v_dot2_f32_bf16 v21, v121, v10, v21
  v_dot2_f32_bf16 v21, v122, v12, v21
  v_dot2_f32_bf16 v21, v123, v14, v21
  s_nop 2
  v_permlane16_swap_b32 v20, v21
  v_add_f32 v23, v20, v21
  v_add_f32_dpp v25, v22, v22 row_ror:8 row_mask:0xf bank_mask:0x3
  s_nop 1
  v_add_f32_dpp v25, v23, v23 row_ror:8 row_mask:0xf bank_mask:0xc
  v_add_f32_dpp v26, v24, v24 row_shl:4 row_mask:0xf bank_mask:0x5
  s_nop 1
  v_add_f32_dpp v26, v25, v25 row_shr:4 row_mask:0xf bank_mask:0xa
  s_waitcnt vmcnt(5)
  buffer_load_dwordx4 v[84:87], v2, s[48:51], s56 offen nt
  s_add_u32 s56, s56, 4096
  v_dot2_f32_bf16 v20, v124, v8, 0
  v_dot2_f32_bf16 v20, v125, v10, v20
  v_dot2_f32_bf16 v20, v126, v12, v20
  v_dot2_f32_bf16 v20, v127, v14, v20
  s_waitcnt vmcnt(5)
  buffer_load_dwordx4 v[88:91], v2, s[48:51], s56 offen nt
  s_add_u32 s56, s56, 4096
  v_dot2_f32_bf16 v21, v64, v8, 0
  v_dot2_f32_bf16 v21, v65, v10, v21
  v_dot2_f32_bf16 v21, v66, v12, v21
  v_dot2_f32_bf16 v21, v67, v14, v21
  s_nop 2
  v_permlane16_swap_b32 v20, v21
  v_add_f32 v22, v20, v21
  s_waitcnt vmcnt(5)
  buffer_load_dwordx4 v[92:95], v2, s[48:51], s56 offen nt
  s_add_u32 s56, s56, 4096
  v_dot2_f32_bf16 v20, v68, v8, 0
  v_dot2_f32_bf16 v20, v69, v10, v20
  v_dot2_f32_bf16 v20, v70, v12, v20
  v_dot2_f32_bf16 v20, v71, v14, v20
  s_waitcnt vmcnt(5)
  buffer_load_dwordx4 v[96:99], v2, s[48:51], s56 offen nt
  s_add_u32 s56, s56, 4096
  v_dot2_f32_bf16 v21, v72, v8, 0
  v_dot2_f32_bf16 v21, v73, v10, v21
  v_dot2_f32_bf16 v21, v74, v12, v21
  v_dot2_f32_bf16 v21, v75, v14, v21
  s_nop 2
  v_permlane16_swap_b32 v20, v21
  v_add_f32 v23, v20, v21
  v_add_f32_dpp v24, v22, v22 row_ror:8 row_mask:0xf bank_mask:0x3
  s_nop 1
  v_add_f32_dpp v24, v23, v23 row_ror:8 row_mask:0xf bank_mask:0xc
  s_waitcnt vmcnt(5)
  buffer_load_dwordx4 v[100:103], v2, s[48:51], s56 offen nt
  s_add_u32 s56, s56, 4096
  v_dot2_f32_bf16 v20, v76, v8, 0
  v_dot2_f32_bf16 v20, v77, v10, v20
  v_dot2_f32_bf16 v20, v78, v12, v20
  v_dot2_f32_bf16 v20, v79, v14, v20
  s_waitcnt vmcnt(5)
  buffer_load_dwordx4 v[104:107], v2, s[48:51], s56 offen nt
  s_add_u32 s56, s56, 4096
  v_dot2_f32_bf16 v21, v80, v8, 0
  v_dot2_f32_bf16 v21, v81, v10, v21
  v_dot2_f32_bf16 v21, v82, v12, v21
  v_dot2_f32_bf16 v21, v83, v14, v21
  s_nop 2
  v_permlane16_swap_b32 v20, v21
  v_add_f32 v22, v20, v21
  s_waitcnt vmcnt(5)
  buffer_load_dwordx4 v[108:111], v2, s[48:51], s56 offen nt
  s_add_u32 s56, s56, 4096
  v_dot2_f32_bf16 v20, v84, v8, 0
  v_dot2_f32_bf16 v20, v85, v10, v20
  v_dot2_f32_bf16 v20, v86, v12, v20
  v_dot2_f32_bf16 v20, v87, v14, v20
  s_waitcnt vmcnt(5)
  buffer_load_dwordx4 v[112:115], v2, s[48:51], s56 offen nt
  s_add_u32 s56, s56, 4096
  v_dot2_f32_bf16 v21, v88, v8, 0
  v_dot2_f32_bf16 v21, v89, v10, v21
  v_dot2_f32_bf16 v21, v90, v12, v21
  v_dot2_f32_bf16 v21, v91, v14, v21
  s_nop 2
  v_permlane16_swap_b32 v20, v21
  v_add_f32 v23, v20, v21
  v_add_f32_dpp v25, v22, v22 row_ror:8 row_mask:0xf bank_mask:0x3
  s_nop 1
  v_add_f32_dpp v25, v23, v23 row_ror:8 row_mask:0xf bank_mask:0xc
  v_add_f32_dpp v27, v24, v24 row_shl:4 row_mask:0xf bank_mask:0x5
  s_nop 1
  v_add_f32_dpp v27, v25, v25 row_shr:4 row_mask:0xf bank_mask:0xa
  v_add_f32_dpp v30, v26, v26 quad_perm:[2,3,0,1] row_mask:0xf bank_mask:0xf
  s_nop 0
  v_add_f32_dpp v31, v27, v27 quad_perm:[2,3,0,1] row_mask:0xf bank_mask:0xf
  v_cndmask_b32 v29, v30, v31, s[60:61]
  v_add_f32_dpp v30, v28, v28 quad_perm:[1,0,3,2] row_mask:0xf bank_mask:0xf
  s_nop 0
  v_add_f32_dpp v31, v29, v29 quad_perm:[1,0,3,2] row_mask:0xf bank_mask:0xf
  v_cndmask_b32 v32, v30, v31, s[62:63]
  ds_write_b32 v16, v32 offset:15776
  v_add_u32 v16, 48, v16
  s_mov_b32 s58, 4
L_KLOOP:
  s_waitcnt vmcnt(5)
  buffer_load_dwordx4 v[116:119], v2, s[48:51], s56 offen nt
  s_add_u32 s56, s56, 4096
  v_dot2_f32_bf16 v20, v92, v8, 0
  v_dot2_f32_bf16 v20, v93, v10, v20
  v_dot2_f32_bf16 v20, v94, v12, v20
  v_dot2_f32_bf16 v20, v95, v14, v20
  s_waitcnt vmcnt(5)
  buffer_load_dwordx4 v[120:123], v2, s[48:51], s56 offen nt
  s_add_u32 s56, s56, 4096
  v_dot2_f32_bf16 v21, v96, v8, 0
  v_dot2_f32_bf16 v21, v97, v10, v21
  v_dot2_f32_bf16 v21, v98, v12, v21
  v_dot2_f32_bf16 v21, v99, v14, v21
  s_nop 2
  v_permlane16_swap_b32 v20, v21
  v_add_f32 v22, v20, v21
  s_waitcnt vmcnt(5)
  buffer_load_dwordx4 v[124:127], v2, s[48:51], s56 offen nt
  s_add_u32 s56, s56, 4096
  v_dot2_f32_bf16 v20, v100, v8, 0
  v_dot2_f32_bf16 v20, v101, v10, v20
  v_dot2_f32_bf16 v20, v102, v12, v20
  v_dot2_f32_bf16 v20, v103, v14, v20
  s_waitcnt vmcnt(5)
  buffer_load_dwordx4 v[64:67], v2, s[48:51], s56 offen nt
  s_add_u32 s56, s56, 4096
  v_dot2_f32_bf16 v21, v104, v8, 0
  v_dot2_f32_bf16 v21, v105, v10, v21
  v_dot2_f32_bf16 v21, v106, v12, v21
  v_dot2_f32_bf16 v21, v107, v14, v21
  s_nop 2
  v_permlane16_swap_b32 v20, v21
  v_add_f32 v23, v20, v21
  v_add_f32_dpp v24, v22, v22 row_ror:8 row_mask:0xf bank_mask:0x3
  s_nop 1
  v_add_f32_dpp v24, v23, v23 row_ror:8 row_mask:0xf bank_mask:0xc
  s_waitcnt vmcnt(5)
  buffer_load_dwordx4 v[68:71], v2, s[48:51], s56 offen nt
  s_add_u32 s56, s56, 4096
  v_dot2_f32_bf16 v20, v108, v8, 0
  v_dot2_f32_bf16 v20, v109, v10, v20
  v_dot2_f32_bf16 v20, v110, v12, v20
  v_dot2_f32_bf16 v20, v111, v14, v20
  s_waitcnt vmcnt(5)
  buffer_load_dwordx4 v[72:75], v2, s[48:51], s56 offen nt
  s_add_u32 s56, s56, 4096
  v_dot2_f32_bf16 v21, v112, v8, 0
  v_dot2_f32_bf16 v21, v113, v10, v21
  v_dot2_f32_bf16 v21, v114, v12, v21
  v_dot2_f32_bf16 v21, v115, v14, v21
  s_nop 2
  v_permlane16_swap_b32 v20, v21
  v_add_f32 v22, v20, v21
  s_waitcnt vmcnt(5)
  buffer_load_dwordx4 v[76:79], v2, s[48:51], s56 offen nt
  s_add_u32 s56, s56, 4096
  v_dot2_f32_bf16 v20, v116, v8, 0
  v_dot2_f32_bf16 v20, v117, v10, v20
  v_dot2_f32_bf16 v20, v118, v12, v20
  v_dot2_f32_bf16 v20, v119, v14, v20
  s_waitcnt vmcnt(5)
  buffer_load_dwordx4 v[80:83], v2, s[48:51], s56 offen nt
  s_add_u32 s56, s56, 4096
  v_dot2_f32_bf16 v21, v120, v8, 0
  v_dot2_f32_bf16 v21, v121, v10, v21
  v_dot2_f32_bf16 v21, v122, v12, v21
  v_dot2_f32_bf16 v21, v123, v14, v21
  s_nop 2
  v_permlane16_swap_b32 v20, v21
  v_add_f32 v23, v20, v21
  v_add_f32_dpp v25, v22, v22 row_ror:8 row_mask:0xf bank_mask:0x3
  s_nop 1
  v_add_f32_dpp v25, v23, v23 row_ror:8 row_mask:0xf bank_mask:0xc
  v_add_f32_dpp v26, v24, v24 row_shl:4 row_mask:0xf bank_mask:0x5
  s_nop 1
  v_add_f32_dpp v26, v25, v25 row_shr:4 row_mask:0xf bank_mask:0xa
  s_waitcnt vmcnt(5)
  buffer_load_dwordx4 v[84:87], v2, s[48:51], s56 offen nt
  s_add_u32 s56, s56, 4096
  v_dot2_f32_bf16 v20, v124, v8, 0
  v_dot2_f32_bf16 v20, v125, v10, v20
  v_dot2_f32_bf16 v20, v126, v12, v20
  v_dot2_f32_bf16 v20, v127, v14, v20
  s_waitcnt vmcnt(5)
  buffer_load_dwordx4 v[88:91], v2, s[48:51], s56 offen nt
  s_add_u32 s56, s56, 4096
  v_dot2_f32_bf16 v21, v64, v8, 0
  v_dot2_f32_bf16 v21, v65, v10, v21
  v_dot2_f32_bf16 v21, v66, v12, v21
  v_dot2_f32_bf16 v21, v67, v14, v21
  s_nop 2
  v_permlane16_swap_b32 v20, v21
  v_add_f32 v22, v20, v21
  s_waitcnt vmcnt(5)
  buffer_load_dwordx4 v[92:95], v2, s[48:51], s56 offen nt
  s_add_u32 s56, s56, 4096
  v_dot2_f32_bf16 v20, v68, v8, 0
  v_dot2_f32_bf16 v20, v69, v10, v20
  v_dot2_f32_bf16 v20, v70, v12, v20
  v_dot2_f32_bf16 v20, v71, v14, v20
  s_waitcnt vmcnt(5)
  buffer_load_dwordx4 v[96:99], v2, s[48:51], s56 offen nt
  s_add_u32 s56, s56, 4096
  v_dot2_f32_bf16 v21, v72, v8, 0
  v_dot2_f32_bf16 v21, v73, v10, v21
  v_dot2_f32_bf16 v21, v74, v12, v21
  v_dot2_f32_bf16 v21, v75, v14, v21
  s_nop 2
  v_permlane16_swap_b32 v20, v21
  v_add_f32 v23, v20, v21
  v_add_f32_dpp v24, v22, v22 row_ror:8 row_mask:0xf bank_mask:0x3
  s_nop 1
  v_add_f32_dpp v24, v23, v23 row_ror:8 row_mask:0xf bank_mask:0xc
  s_waitcnt vmcnt(5)
  buffer_load_dwordx4 v[100:103], v2, s[48:51], s56 offen nt
  s_add_u32 s56, s56, 4096
  v_dot2_f32_bf16 v20, v76, v8, 0
  v_dot2_f32_bf16 v20, v77, v10, v20
  v_dot2_f32_bf16 v20, v78, v12, v20
  v_dot2_f32_bf16 v20, v79, v14, v20
  s_waitcnt vmcnt(5)
  buffer_load_dwordx4 v[104:107], v2, s[48:51], s56 offen nt
  s_add_u32 s56, s56, 4096
  v_dot2_f32_bf16 v21, v80, v8, 0
  v_dot2_f32_bf16 v21, v81, v10, v21
  v_dot2_f32_bf16 v21, v82, v12, v21
  v_dot2_f32_bf16 v21, v83, v14, v21
  s_nop 2
  v_permlane16_swap_b32 v20, v21
  v_add_f32 v22, v20, v21
  s_waitcnt vmcnt(5)
  buffer_load_dwordx4 v[108:111], v2, s[48:51], s56 offen nt
  s_add_u32 s56, s56, 4096
  v_dot2_f32_bf16 v20, v84, v8, 0
  v_dot2_f32_bf16 v20, v85, v10, v20
  v_dot2_f32_bf16 v20, v86, v12, v20
  v_dot2_f32_bf16 v20, v87, v14, v20
  s_waitcnt vmcnt(5)
  buffer_load_dwordx4 v[112:115], v2, s[48:51], s56 offen nt
  s_add_u32 s56, s56, 4096
  v_dot2_f32_bf16 v21, v88, v8, 0
  v_dot2_f32_bf16 v21, v89, v10, v21
  v_dot2_f32_bf16 v21, v90, v12, v21
  v_dot2_f32_bf16 v21, v91, v14, v21
  s_nop 2
  v_permlane16_swap_b32 v20, v21
  v_add_f32 v23, v20, v21
  v_add_f32_dpp v25, v22, v22 row_ror:8 row_mask:0xf bank_mask:0x3
  s_nop 1
  v_add_f32_dpp v25, v23, v23 row_ror:8 row_mask:0xf bank_mask:0xc
  v_add_f32_dpp v27, v24, v24 row_shl:4 row_mask:0xf bank_mask:0x5
  s_nop 1
  v_add_f32_dpp v27, v25, v25 row_shr:4 row_mask:0xf bank_mask:0xa
  v_add_f32_dpp v30, v26, v26 quad_perm:[2,3,0,1] row_mask:0xf bank_mask:0xf
  s_nop 0
  v_add_f32_dpp v31, v27, v27 quad_perm:[2,3,0,1] row_mask:0xf bank_mask:0xf
  v_cndmask_b32 v28, v30, v31, s[60:61]
  s_waitcnt vmcnt(5)
  buffer_load_dwordx4 v[116:119], v2, s[48:51], s56 offen nt
  s_add_u32 s56, s56, 4096
  v_dot2_f32_bf16 v20, v92, v8, 0
  v_dot2_f32_bf16 v20, v93, v10, v20
  v_dot2_f32_bf16 v20, v94, v12, v20
  v_dot2_f32_bf16 v20, v95, v14, v20
  s_waitcnt vmcnt(5)
  buffer_load_dwordx4 v[120:123], v2, s[48:51], s56 offen nt
  s_add_u32 s56, s56, 4096
  v_dot2_f32_bf16 v21, v96, v8, 0
  v_dot2_f32_bf16 v21, v97, v10, v21
  v_dot2_f32_bf16 v21, v98, v12, v21
  v_dot2_f32_bf16 v21, v99, v14, v21
  s_nop 2
  v_permlane16_swap_b32 v20, v21
  v_add_f32 v22, v20, v21
  s_waitcnt vmcnt(5)
  buffer_load_dwordx4 v[124:127], v2, s[48:51], s56 offen nt
  s_add_u32 s56, s56, 4096
  v_dot2_f32_bf16 v20, v100, v8, 0
  v_dot2_f32_bf16 v20, v101, v10, v20
  v_dot2_f32_bf16 v20, v102, v12, v20
  v_dot2_f32_bf16 v20, v103, v14, v20
  s_waitcnt vmcnt(5)
  buffer_load_dwordx4 v[64:67], v2, s[48:51], s56 offen nt
  s_add_u32 s56, s56, 4096
  v_dot2_f32_bf16 v21, v104, v8, 0
  v_dot2_f32_bf16 v21, v105, v10, v21
  v_dot2_f32_bf16 v21, v106, v12, v21
  v_dot2_f32_bf16 v21, v107, v14, v21
  s_nop 2
  v_permlane16_swap_b32 v20, v21
  v_add_f32 v23, v20, v21
  v_add_f32_dpp v24, v22, v22 row_ror:8 row_mask:0xf bank_mask:0x3
  s_nop 1
  v_add_f32_dpp v24, v23, v23 row_ror:8 row_mask:0xf bank_mask:0xc
  s_waitcnt vmcnt(5)
  buffer_load_dwordx4 v[68:71], v2, s[48:51], s56 offen nt
  s_add_u32 s56, s56, 4096
  v_dot2_f32_bf16 v20, v108, v8, 0
  v_dot2_f32_bf16 v20, v109, v10, v20
  v_dot2_f32_bf16 v20, v110, v12, v20
  v_dot2_f32_bf16 v20, v111, v14, v20
  s_waitcnt vmcnt(5)
  buffer_load_dwordx4 v[72:75], v2, s[48:51], s56 offen nt
  s_add_u32 s56, s56, 4096
  v_dot2_f32_bf16 v21, v112, v8, 0
  v_dot2_f32_bf16 v21, v113, v10, v21
  v_dot2_f32_bf16 v21, v114, v12, v21
  v_dot2_f32_bf16 v21, v115, v14, v21
  s_nop 2
  v_permlane16_swap_b32 v20, v21
  v_add_f32 v22, v20, v21
  s_waitcnt vmcnt(5)
  buffer_load_dwordx4 v[76:79], v2, s[48:51], s56 offen nt
  s_add_u32 s56, s56, 4096
  v_dot2_f32_bf16 v20, v116, v8, 0
  v_dot2_f32_bf16 v20, v117, v10, v20
  v_dot2_f32_bf16 v20, v118, v12, v20
  v_dot2_f32_bf16 v20, v119, v14, v20
  s_waitcnt vmcnt(5)
  buffer_load_dwordx4 v[80:83], v2, s[48:51], s56 offen nt
  s_add_u32 s56, s56, 4096
  v_dot2_f32_bf16 v21, v120, v8, 0
  v_dot2_f32_bf16 v21, v121, v10, v21
  v_dot2_f32_bf16 v21, v122, v12, v21
  v_dot2_f32_bf16 v21, v123, v14, v21
  s_nop 2
  v_permlane16_swap_b32 v20, v21
  v_add_f32 v23, v20, v21
  v_add_f32_dpp v25, v22, v22 row_ror:8 row_mask:0xf bank_mask:0x3
  s_nop 1
  v_add_f32_dpp v25, v23, v23 row_ror:8 row_mask:0xf bank_mask:0xc
  v_add_f32_dpp v26, v24, v24 row_shl:4 row_mask:0xf bank_mask:0x5
  s_nop 1
  v_add_f32_dpp v26, v25, v25 row_shr:4 row_mask:0xf bank_mask:0xa
  s_waitcnt vmcnt(5)
  buffer_load_dwordx4 v[84:87], v2, s[48:51], s56 offen nt
  s_add_u32 s56, s56, 4096
  v_dot2_f32_bf16 v20, v124, v8, 0
  v_dot2_f32_bf16 v20, v125, v10, v20
  v_dot2_f32_bf16 v20, v126, v12, v20
  v_dot2_f32_bf16 v20, v127, v14, v20
  s_waitcnt vmcnt(5)
  buffer_load_dwordx4 v[88:91], v2, s[48:51], s56 offen nt
  s_add_u32 s56, s56, 4096
  v_dot2_f32_bf16 v21, v64, v8, 0
  v_dot2_f32_bf16 v21, v65, v10, v21
  v_dot2_f32_bf16 v21, v66, v12, v21
  v_dot2_f32_bf16 v21, v67, v14, v21
  s_nop 2
  v_permlane16_swap_b32 v20, v21
  v_add_f32 v22, v20, v21
  s_waitcnt vmcnt(5)
  buffer_load_dwordx4 v[92:95], v2, s[48:51], s56 offen nt
  s_add_u32 s56, s56, 4096
  v_dot2_f32_bf16 v20, v68, v8, 0
  v_dot2_f32_bf16 v20, v69, v10, v20
  v_dot2_f32_bf16 v20, v70, v12, v20
  v_dot2_f32_bf16 v20, v71, v14, v20
  s_waitcnt vmcnt(5)
  buffer_load_dwordx4 v[96:99], v2, s[48:51], s56 offen nt
  s_add_u32 s56, s56, 4096
  v_dot2_f32_bf16 v21, v72, v8, 0
  v_dot2_f32_bf16 v21, v73, v10, v21
  v_dot2_f32_bf16 v21, v74, v12, v21
  v_dot2_f32_bf16 v21, v75, v14, v21
  s_nop 2
  v_permlane16_swap_b32 v20, v21
  v_add_f32 v23, v20, v21
  v_add_f32_dpp v24, v22, v22 row_ror:8 row_mask:0xf bank_mask:0x3
  s_nop 1
  v_add_f32_dpp v24, v23, v23 row_ror:8 row_mask:0xf bank_mask:0xc
  s_waitcnt vmcnt(5)
  buffer_load_dwordx4 v[100:103], v2, s[48:51], s56 offen nt
  s_add_u32 s56, s56, 4096
  v_dot2_f32_bf16 v20, v76, v8, 0
  v_dot2_f32_bf16 v20, v77, v10, v20
  v_dot2_f32_bf16 v20, v78, v12, v20
  v_dot2_f32_bf16 v20, v79, v14, v20
  s_waitcnt vmcnt(5)
  buffer_load_dwordx4 v[104:107], v2, s[48:51], s56 offen nt
  s_add_u32 s56, s56, 4096
  v_dot2_f32_bf16 v21, v80, v8, 0
  v_dot2_f32_bf16 v21, v81, v10, v21
  v_dot2_f32_bf16 v21, v82, v12, v21
  v_dot2_f32_bf16 v21, v83, v14, v21
  s_nop 2
  v_permlane16_swap_b32 v20, v21
  v_add_f32 v22, v20, v21
  s_waitcnt vmcnt(5)
  buffer_load_dwordx4 v[108:111], v2, s[48:51], s56 offen nt
  s_add_u32 s56, s56, 4096
  v_dot2_f32_bf16 v20, v84, v8, 0
  v_dot2_f32_bf16 v20, v85, v10, v20
  v_dot2_f32_bf16 v20, v86, v12, v20
  v_dot2_f32_bf16 v20, v87, v14, v20
  s_waitcnt vmcnt(5)
  buffer_load_dwordx4 v[112:115], v2, s[48:51], s56 offen nt
  s_add_u32 s56, s56, 4096
  v_dot2_f32_bf16 v21, v88, v8, 0
  v_dot2_f32_bf16 v21, v89, v10, v21
  v_dot2_f32_bf16 v21, v90, v12, v21
  v_dot2_f32_bf16 v21, v91, v14, v21
  s_nop 2
  v_permlane16_swap_b32 v20, v21
  v_add_f32 v23, v20, v21
  v_add_f32_dpp v25, v22, v22 row_ror:8 row_mask:0xf bank_mask:0x3
  s_nop 1
  v_add_f32_dpp v25, v23, v23 row_ror:8 row_mask:0xf bank_mask:0xc
  v_add_f32_dpp v27, v24, v24 row_shl:4 row_mask:0xf bank_mask:0x5
  s_nop 1
  v_add_f32_dpp v27, v25, v25 row_shr:4 row_mask:0xf bank_mask:0xa
  v_add_f32_dpp v30, v26, v26 quad_perm:[2,3,0,1] row_mask:0xf bank_mask:0xf
  s_nop 0
  v_add_f32_dpp v31, v27, v27 quad_perm:[2,3,0,1] row_mask:0xf bank_mask:0xf
  v_cndmask_b32 v29, v30, v31, s[60:61]
  v_add_f32_dpp v30, v28, v28 quad_perm:[1,0,3,2] row_mask:0xf bank_mask:0xf
  s_nop 0
  v_add_f32_dpp v31, v29, v29 quad_perm:[1,0,3,2] row_mask:0xf bank_mask:0xf
  v_cndmask_b32 v32, v30, v31, s[62:63]
  ds_write_b32 v16, v32 offset:15744
  v_add_u32 v16, 16, v16
  s_sub_u32 s58, s58, 1
  s_cmp_lg_u32 s58, 0
  s_cbranch_scc1 L_KLOOP
  s_waitcnt vmcnt(5)
  buffer_load_dwordx4 v[116:119], v2, s[48:51], s56 offen nt
  s_add_u32 s56, s56, 4096
  v_dot2_f32_bf16 v20, v92, v8, 0
  v_dot2_f32_bf16 v20, v93, v10, v20
  v_dot2_f32_bf16 v20, v94, v12, v20
  v_dot2_f32_bf16 v20, v95, v14, v20
  s_waitcnt vmcnt(5)
  buffer_load_dwordx4 v[120:123], v2, s[48:51], s56 offen nt
  s_add_u32 s56, s56, 4096
  v_dot2_f32_bf16 v21, v96, v8, 0
  v_dot2_f32_bf16 v21, v97, v10, v21
  v_dot2_f32_bf16 v21, v98, v12, v21
  v_dot2_f32_bf16 v21, v99, v14, v21
  s_nop 2
  v_permlane16_swap_b32 v20, v21
  v_add_f32 v22, v20, v21
  s_waitcnt vmcnt(5)
  buffer_load_dwordx4 v[124:127], v2, s[48:51], s56 offen nt
  s_add_u32 s56, s56, 4096
  v_dot2_f32_bf16 v20, v100, v8, 0
  v_dot2_f32_bf16 v20, v101, v10, v20
  v_dot2_f32_bf16 v20, v102, v12, v20
  v_dot2_f32_bf16 v20, v103, v14, v20
  s_waitcnt vmcnt(5)
  buffer_load_dwordx4 v[64:67], v2, s[48:51], s56 offen nt
  s_add_u32 s56, s56, 4096
  v_dot2_f32_bf16 v21, v104, v8, 0
  v_dot2_f32_bf16 v21, v105, v10, v21
  v_dot2_f32_bf16 v21, v106, v12, v21
  v_dot2_f32_bf16 v21, v107, v14, v21
  s_nop 2
  v_permlane16_swap_b32 v20, v21
  v_add_f32 v23, v20, v21
  v_add_f32_dpp v24, v22, v22 row_ror:8 row_mask:0xf bank_mask:0x3
  s_nop 1
  v_add_f32_dpp v24, v23, v23 row_ror:8 row_mask:0xf bank_mask:0xc
  s_waitcnt vmcnt(5)
  buffer_load_dwordx4 v[68:71], v2, s[48:51], s56 offen nt
  s_add_u32 s56, s56, 4096
  v_dot2_f32_bf16 v20, v108, v8, 0
  v_dot2_f32_bf16 v20, v109, v10, v20
  v_dot2_f32_bf16 v20, v110, v12, v20
  v_dot2_f32_bf16 v20, v111, v14, v20
  s_waitcnt vmcnt(5)
  buffer_load_dwordx4 v[72:75], v2, s[48:51], s56 offen nt
  s_add_u32 s56, s56, 4096
  v_dot2_f32_bf16 v21, v112, v8, 0
  v_dot2_f32_bf16 v21, v113, v10, v21
  v_dot2_f32_bf16 v21, v114, v12, v21
  v_dot2_f32_bf16 v21, v115, v14, v21
  s_nop 2
  v_permlane16_swap_b32 v20, v21
  v_add_f32 v22, v20, v21
  s_waitcnt vmcnt(5)
  buffer_load_dwordx4 v[76:79], v2, s[48:51], s56 offen nt
  s_add_u32 s56, s56, 4096
  v_dot2_f32_bf16 v20, v116, v8, 0
  v_dot2_f32_bf16 v20, v117, v10, v20
  v_dot2_f32_bf16 v20, v118, v12, v20
  v_dot2_f32_bf16 v20, v119, v14, v20
  s_waitcnt vmcnt(5)
  buffer_load_dwordx4 v[80:83], v2, s[48:51], s56 offen nt
  s_add_u32 s56, s56, 4096
  v_dot2_f32_bf16 v21, v120, v8, 0
  v_dot2_f32_bf16 v21, v121, v10, v21
  v_dot2_f32_bf16 v21, v122, v12, v21
  v_dot2_f32_bf16 v21, v123, v14, v21
  s_nop 2
  v_permlane16_swap_b32 v20, v21
  v_add_f32 v23, v20, v21
  v_add_f32_dpp v25, v22, v22 row_ror:8 row_mask:0xf bank_mask:0x3
  s_nop 1
  v_add_f32_dpp v25, v23, v23 row_ror:8 row_mask:0xf bank_mask:0xc
  v_add_f32_dpp v26, v24, v24 row_shl:4 row_mask:0xf bank_mask:0x5
  s_nop 1
  v_add_f32_dpp v26, v25, v25 row_shr:4 row_mask:0xf bank_mask:0xa
  s_waitcnt vmcnt(5)
  buffer_load_dwordx4 v[84:87], v2, s[48:51], s56 offen nt
  s_add_u32 s56, s56, 4096
  v_dot2_f32_bf16 v20, v124, v8, 0
  v_dot2_f32_bf16 v20, v125, v10, v20
  v_dot2_f32_bf16 v20, v126, v12, v20
  v_dot2_f32_bf16 v20, v127, v14, v20
  s_waitcnt vmcnt(5)
  buffer_load_dwordx4 v[88:91], v2, s[48:51], s56 offen nt
  s_add_u32 s56, s56, 4096
  v_dot2_f32_bf16 v21, v64, v8, 0
  v_dot2_f32_bf16 v21, v65, v10, v21
  v_dot2_f32_bf16 v21, v66, v12, v21
  v_dot2_f32_bf16 v21, v67, v14, v21
  s_nop 2
  v_permlane16_swap_b32 v20, v21
  v_add_f32 v22, v20, v21
  s_waitcnt vmcnt(5)
  buffer_load_dwordx4 v[92:95], v2, s[48:51], s56 offen nt
  s_add_u32 s56, s56, 4096
  v_dot2_f32_bf16 v20, v68, v8, 0
  v_dot2_f32_bf16 v20, v69, v10, v20
  v_dot2_f32_bf16 v20, v70, v12, v20
  v_dot2_f32_bf16 v20, v71, v14, v20
  s_waitcnt vmcnt(5)
  buffer_load_dwordx4 v[96:99], v2, s[48:51], s56 offen nt
  s_add_u32 s56, s56, 4096
  v_dot2_f32_bf16 v21, v72, v8, 0
  v_dot2_f32_bf16 v21, v73, v10, v21
  v_dot2_f32_bf16 v21, v74, v12, v21
  v_dot2_f32_bf16 v21, v75, v14, v21
  s_nop 2
  v_permlane16_swap_b32 v20, v21
  v_add_f32 v23, v20, v21
  v_add_f32_dpp v24, v22, v22 row_ror:8 row_mask:0xf bank_mask:0x3
  s_nop 1
  v_add_f32_dpp v24, v23, v23 row_ror:8 row_mask:0xf bank_mask:0xc
  s_waitcnt vmcnt(5)
  buffer_load_dwordx4 v[100:103], v2, s[48:51], s56 offen nt
  s_add_u32 s56, s56, 4096
  v_dot2_f32_bf16 v20, v76, v8, 0
  v_dot2_f32_bf16 v20, v77, v10, v20
  v_dot2_f32_bf16 v20, v78, v12, v20
  v_dot2_f32_bf16 v20, v79, v14, v20
  s_waitcnt vmcnt(5)
  buffer_load_dwordx4 v[104:107], v2, s[48:51], s56 offen nt
  s_add_u32 s56, s56, 4096
  v_dot2_f32_bf16 v21, v80, v8, 0
  v_dot2_f32_bf16 v21, v81, v10, v21
  v_dot2_f32_bf16 v21, v82, v12, v21
  v_dot2_f32_bf16 v21, v83, v14, v21
  s_nop 2
  v_permlane16_swap_b32 v20, v21
  v_add_f32 v22, v20, v21
  s_waitcnt vmcnt(5)
  buffer_load_dwordx4 v[108:111], v2, s[48:51], s56 offen nt
  s_add_u32 s56, s56, 4096
  v_dot2_f32_bf16 v20, v84, v8, 0
  v_dot2_f32_bf16 v20, v85, v10, v20
  v_dot2_f32_bf16 v20, v86, v12, v20
  v_dot2_f32_bf16 v20, v87, v14, v20
  s_waitcnt vmcnt(5)
  buffer_load_dwordx4 v[112:115], v2, s[48:51], s56 offen nt
  s_add_u32 s56, s56, 4096
  v_dot2_f32_bf16 v21, v88, v8, 0
  v_dot2_f32_bf16 v21, v89, v10, v21
  v_dot2_f32_bf16 v21, v90, v12, v21
  v_dot2_f32_bf16 v21, v91, v14, v21
  s_nop 2
  v_permlane16_swap_b32 v20, v21
  v_add_f32 v23, v20, v21
  v_add_f32_dpp v25, v22, v22 row_ror:8 row_mask:0xf bank_mask:0x3
  s_nop 1
  v_add_f32_dpp v25, v23, v23 row_ror:8 row_mask:0xf bank_mask:0xc
  v_add_f32_dpp v27, v24, v24 row_shl:4 row_mask:0xf bank_mask:0x5
  s_nop 1
  v_add_f32_dpp v27, v25, v25 row_shr:4 row_mask:0xf bank_mask:0xa
  v_add_f32_dpp v30, v26, v26 quad_perm:[2,3,0,1] row_mask:0xf bank_mask:0xf
  s_nop 0
  v_add_f32_dpp v31, v27, v27 quad_perm:[2,3,0,1] row_mask:0xf bank_mask:0xf
  v_cndmask_b32 v28, v30, v31, s[60:61]
  s_waitcnt vmcnt(5)
  buffer_load_dwordx4 v[116:119], v2, s[48:51], s56 offen nt
  s_add_u32 s56, s56, 4096
  v_dot2_f32_bf16 v20, v92, v8, 0
  v_dot2_f32_bf16 v20, v93, v10, v20
  v_dot2_f32_bf16 v20, v94, v12, v20
  v_dot2_f32_bf16 v20, v95, v14, v20
  s_waitcnt vmcnt(5)
  buffer_load_dwordx4 v[120:123], v2, s[48:51], s56 offen nt
  s_add_u32 s56, s56, 4096
  v_dot2_f32_bf16 v21, v96, v8, 0
  v_dot2_f32_bf16 v21, v97, v10, v21
  v_dot2_f32_bf16 v21, v98, v12, v21
  v_dot2_f32_bf16 v21, v99, v14, v21
  s_nop 2
  v_permlane16_swap_b32 v20, v21
  v_add_f32 v22, v20, v21
  s_waitcnt vmcnt(5)
  buffer_load_dwordx4 v[124:127], v2, s[48:51], s56 offen nt
  s_add_u32 s56, s56, 4096
  v_dot2_f32_bf16 v20, v100, v8, 0
  v_dot2_f32_bf16 v20, v101, v10, v20
  v_dot2_f32_bf16 v20, v102, v12, v20
  v_dot2_f32_bf16 v20, v103, v14, v20
  s_waitcnt vmcnt(5)
  buffer_load_dwordx4 v[64:67], v2, s[48:51], s56 offen nt
  s_add_u32 s56, s56, 4096
  v_dot2_f32_bf16 v21, v104, v8, 0
  v_dot2_f32_bf16 v21, v105, v10, v21
  v_dot2_f32_bf16 v21, v106, v12, v21
  v_dot2_f32_bf16 v21, v107, v14, v21
  s_nop 2
  v_permlane16_swap_b32 v20, v21
  v_add_f32 v23, v20, v21
  v_add_f32_dpp v24, v22, v22 row_ror:8 row_mask:0xf bank_mask:0x3
  s_nop 1
  v_add_f32_dpp v24, v23, v23 row_ror:8 row_mask:0xf bank_mask:0xc
  s_waitcnt vmcnt(5)
  buffer_load_dwordx4 v[68:71], v2, s[48:51], s56 offen nt
  s_add_u32 s56, s56, 4096
  v_dot2_f32_bf16 v20, v108, v8, 0
  v_dot2_f32_bf16 v20, v109, v10, v20
  v_dot2_f32_bf16 v20, v110, v12, v20
  v_dot2_f32_bf16 v20, v111, v14, v20
  s_waitcnt vmcnt(5)
  buffer_load_dwordx4 v[72:75], v2, s[48:51], s56 offen nt
  s_add_u32 s56, s56, 4096
  v_dot2_f32_bf16 v21, v112, v8, 0
  v_dot2_f32_bf16 v21, v113, v10, v21
  v_dot2_f32_bf16 v21, v114, v12, v21
  v_dot2_f32_bf16 v21, v115, v14, v21
  s_nop 2
  v_permlane16_swap_b32 v20, v21
  v_add_f32 v22, v20, v21
  s_waitcnt vmcnt(5)
  buffer_load_dwordx4 v[76:79], v2, s[48:51], s56 offen nt
  s_add_u32 s56, s56, 4096
  v_dot2_f32_bf16 v20, v116, v8, 0
  v_dot2_f32_bf16 v20, v117, v10, v20
  v_dot2_f32_bf16 v20, v118, v12, v20
  v_dot2_f32_bf16 v20, v119, v14, v20
  s_waitcnt vmcnt(5)
  buffer_load_dwordx4 v[80:83], v2, s[48:51], s56 offen nt
  s_add_u32 s56, s56, 4096
  v_dot2_f32_bf16 v21, v120, v8, 0
  v_dot2_f32_bf16 v21, v121, v10, v21
  v_dot2_f32_bf16 v21, v122, v12, v21
  v_dot2_f32_bf16 v21, v123, v14, v21
  s_nop 2
  v_permlane16_swap_b32 v20, v21
  v_add_f32 v23, v20, v21
  v_add_f32_dpp v25, v22, v22 row_ror:8 row_mask:0xf bank_mask:0x3
  s_nop 1
  v_add_f32_dpp v25, v23, v23 row_ror:8 row_mask:0xf bank_mask:0xc
  v_add_f32_dpp v26, v24, v24 row_shl:4 row_mask:0xf bank_mask:0x5
  s_nop 1
  v_add_f32_dpp v26, v25, v25 row_shr:4 row_mask:0xf bank_mask:0xa
  s_waitcnt vmcnt(5)
  buffer_load_dwordx4 v[84:87], v2, s[48:51], s56 offen nt
  s_add_u32 s56, s56, 4096
  v_dot2_f32_bf16 v20, v124, v8, 0
  v_dot2_f32_bf16 v20, v125, v10, v20
  v_dot2_f32_bf16 v20, v126, v12, v20
  v_dot2_f32_bf16 v20, v127, v14, v20
  s_waitcnt vmcnt(5)
  buffer_load_dwordx4 v[88:91], v2, s[48:51], s56 offen nt
  s_add_u32 s56, s56, 4096
  v_dot2_f32_bf16 v21, v64, v8, 0
  v_dot2_f32_bf16 v21, v65, v10, v21
  v_dot2_f32_bf16 v21, v66, v12, v21
  v_dot2_f32_bf16 v21, v67, v14, v21
  s_nop 2
  v_permlane16_swap_b32 v20, v21
  v_add_f32 v22, v20, v21
  s_waitcnt vmcnt(5)
  buffer_load_dwordx4 v[128:131], v3, s[52:55], s57 offen nt
  s_add_u32 s57, s57, 8192
  v_dot2_f32_bf16 v20, v68, v8, 0
  v_dot2_f32_bf16 v20, v69, v10, v20
  v_dot2_f32_bf16 v20, v70, v12, v20
  v_dot2_f32_bf16 v20, v71, v14, v20
  s_waitcnt vmcnt(5)
  buffer_load_dwordx4 v[132:135], v3, s[52:55], s57 offen nt
  s_add_u32 s57, s57, 8192
  v_dot2_f32_bf16 v21, v72, v8, 0
  v_dot2_f32_bf16 v21, v73, v10, v21
  v_dot2_f32_bf16 v21, v74, v12, v21
  v_dot2_f32_bf16 v21, v75, v14, v21
  s_nop 2
  v_permlane16_swap_b32 v20, v21
  v_add_f32 v23, v20, v21
  v_add_f32_dpp v24, v22, v22 row_ror:8 row_mask:0xf bank_mask:0x3
  s_nop 1
  v_add_f32_dpp v24, v23, v23 row_ror:8 row_mask:0xf bank_mask:0xc
  s_waitcnt vmcnt(5)
  buffer_load_dwordx4 v[136:139], v3, s[52:55], s57 offen nt
  s_add_u32 s57, s57, 8192
  v_dot2_f32_bf16 v20, v76, v8, 0
  v_dot2_f32_bf16 v20, v77, v10, v20
  v_dot2_f32_bf16 v20, v78, v12, v20
  v_dot2_f32_bf16 v20, v79, v14, v20
  s_waitcnt vmcnt(5)
  buffer_load_dwordx4 v[140:143], v3, s[52:55], s57 offen nt
  s_add_u32 s57, s57, 8192
  v_dot2_f32_bf16 v21, v80, v8, 0
  v_dot2_f32_bf16 v21, v81, v10, v21
  v_dot2_f32_bf16 v21, v82, v12, v21
  v_dot2_f32_bf16 v21, v83, v14, v21
  s_nop 2
  v_permlane16_swap_b32 v20, v21
  v_add_f32 v22, v20, v21
  s_waitcnt vmcnt(5)
  buffer_load_dwordx4 v[144:147], v3, s[52:55], s57 offen nt
  s_add_u32 s57, s57, 8192
  v_dot2_f32_bf16 v20, v84, v8, 0
  v_dot2_f32_bf16 v20, v85, v10, v20
  v_dot2_f32_bf16 v20, v86, v12, v20
  v_dot2_f32_bf16 v20, v87, v14, v20
  s_waitcnt vmcnt(5)
  buffer_load_dwordx4 v[148:151], v3, s[52:55], s57 offen nt
  s_add_u32 s57, s57, 8192
  v_dot2_f32_bf16 v21, v88, v8, 0
  v_dot2_f32_bf16 v21, v89, v10, v21
  v_dot2_f32_bf16 v21, v90, v12, v21
  v_dot2_f32_bf16 v21, v91, v14, v21
  s_nop 2
  v_permlane16_swap_b32 v20, v21
  v_add_f32 v23, v20, v21
  v_add_f32_dpp v25, v22, v22 row_ror:8 row_mask:0xf bank_mask:0x3
  s_nop 1
  v_add_f32_dpp v25, v23, v23 row_ror:8 row_mask:0xf bank_mask:0xc
  v_add_f32_dpp v27, v24, v24 row_shl:4 row_mask:0xf bank_mask:0x5
  s_nop 1
  v_add_f32_dpp v27, v25, v25 row_shr:4 row_mask:0xf bank_mask:0xa
  v_add_f32_dpp v30, v26, v26 quad_perm:[2,3,0,1] row_mask:0xf bank_mask:0xf
  s_nop 0
  v_add_f32_dpp v31, v27, v27 quad_perm:[2,3,0,1] row_mask:0xf bank_mask:0xf
  v_cndmask_b32 v29, v30, v31, s[60:61]
  v_add_f32_dpp v30, v28, v28 quad_perm:[1,0,3,2] row_mask:0xf bank_mask:0xf
  s_nop 0
  v_add_f32_dpp v31, v29, v29 quad_perm:[1,0,3,2] row_mask:0xf bank_mask:0xf
  v_cndmask_b32 v32, v30, v31, s[62:63]
  ds_write_b32 v16, v32 offset:15744
  s_waitcnt lgkmcnt(0)
  ds_add_u32 v6, v7 offset:8
  v_and_b32 v8, 15, v0
  v_lshlrev_b32 v8, 5, v8
  v_lshrrev_b32 v9, 4, v0
  v_and_b32 v9, 1, v9
  v_lshlrev_b32 v9, 3, v9
  v_add_u32 v8, v8, v9
  v_lshrrev_b32 v9, 5, v0
  v_lshlrev_b32 v9, 2, v9
  v_add_u32 v8, v8, v9
  s_lshl_b32 s64, s39, 9
  v_add_u32 v8, s64, v8
  v_lshlrev_b32 v9, 3, v0
  v_lshrrev_b32 v10, 2, v0
  v_lshlrev_b32 v10, 7, v10
  v_and_b32 v11, 3, v0
  v_lshlrev_b32 v11, 2, v11
  v_add_u32 v10, v10, v11
  s_lshl_b32 s74, s36, 12
  s_lshl_b32 s64, s38, 11
  s_add_u32 s74, s74, s64
  s_lshl_b32 s64, s37, 4
  s_add_u32 s74, s74, s64
  s_add_u32 s74, s74, 327680
  s_waitcnt vmcnt(5)
  buffer_load_dwordx4 v[152:155], v3, s[52:55], s57 offen nt
  s_add_u32 s57, s57, 8192
  s_waitcnt vmcnt(5)
  buffer_load_dwordx4 v[156:159], v3, s[52:55], s57 offen nt
  s_add_u32 s57, s57, 8192
  s_waitcnt vmcnt(5)
  buffer_load_dwordx4 v[160:163], v3, s[52:55], s57 offen nt
  s_add_u32 s57, s57, 8192
  s_waitcnt vmcnt(5)
  buffer_load_dwordx4 v[164:167], v3, s[52:55], s57 offen nt
  s_add_u32 s57, s57, 8192
  s_waitcnt vmcnt(5)
  buffer_load_dwordx4 v[168:171], v3, s[52:55], s57 offen nt
  s_add_u32 s57, s57, 8192
  s_waitcnt vmcnt(5)
  buffer_load_dwordx4 v[172:175], v3, s[52:55], s57 offen nt
  s_add_u32 s57, s57, 8192
  s_waitcnt vmcnt(5)
  buffer_load_dwordx4 v[176:179], v3, s[52:55], s57 offen nt
  s_add_u32 s57, s57, 8192
  s_waitcnt vmcnt(5)
  buffer_load_dwordx4 v[180:183], v3, s[52:55], s57 offen nt
  s_add_u32 s57, s57, 8192
  s_waitcnt vmcnt(5)
  buffer_load_dwordx4 v[184:187], v3, s[52:55], s57 offen nt
  s_add_u32 s57, s57, 8192
  s_waitcnt vmcnt(5)
  buffer_load_dwordx4 v[188:191], v3, s[52:55], s57 offen nt
  s_add_u32 s57, s57, 8192
  s_waitcnt vmcnt(5)
  buffer_load_dwordx4 v[192:195], v3, s[52:55], s57 offen nt
  s_add_u32 s57, s57, 8192
  s_waitcnt vmcnt(5)
  buffer_load_dwordx4 v[196:199], v3, s[52:55], s57 offen nt
  s_add_u32 s57, s57, 8192
  s_waitcnt vmcnt(5)
  buffer_load_dwordx4 v[200:203], v3, s[52:55], s57 offen nt
  s_add_u32 s57, s57, 8192
  s_waitcnt vmcnt(5)
  buffer_load_dwordx4 v[204:207], v3, s[52:55], s57 offen nt
  s_add_u32 s57, s57, 8192
  s_waitcnt vmcnt(5)
  buffer_load_dwordx4 v[208:211], v3, s[52:55], s57 offen nt
  s_add_u32 s57, s57, 8192
  s_waitcnt vmcnt(5)
  buffer_load_dwordx4 v[212:215], v3, s[52:55], s57 offen nt
  s_add_u32 s57, s57, 8192
  s_waitcnt vmcnt(5)
  buffer_load_dwordx4 v[216:219], v3, s[52:55], s57 offen nt
  s_add_u32 s57, s57, 8192
  s_waitcnt vmcnt(5)
  buffer_load_dwordx4 v[220:223], v3, s[52:55], s57 offen nt
  s_add_u32 s57, s57, 8192
  s_waitcnt vmcnt(5)
  buffer_load_dwordx4 v[224:227], v3, s[52:55], s57 offen nt
  s_add_u32 s57, s57, 8192
  s_waitcnt vmcnt(5)
  buffer_load_dwordx4 v[228:231], v3, s[52:55], s57 offen nt
  s_add_u32 s57, s57, 8192
  s_waitcnt vmcnt(5)
  buffer_load_dwordx4 v[232:235], v3, s[52:55], s57 offen nt
  s_add_u32 s57, s57, 8192
  s_waitcnt vmcnt(5)
  buffer_load_dwordx4 v[236:239], v3, s[52:55], s57 offen nt
  s_add_u32 s57, s57, 8192
  s_waitcnt vmcnt(5)
  buffer_load_dwordx4 v[240:243], v3, s[52:55], s57 offen nt
  s_add_u32 s57, s57, 8192
  s_waitcnt vmcnt(5)
  buffer_load_dwordx4 v[244:247], v3, s[52:55], s57 offen nt
  s_add_u32 s57, s57, 8192
  s_waitcnt vmcnt(5)
  buffer_load_dwordx4 v[248:251], v3, s[52:55], s57 offen nt
  s_add_u32 s57, s57, 8192
  s_waitcnt vmcnt(5)
  buffer_load_dwordx4 v[252:255], v3, s[52:55], s57 offen nt
  s_add_u32 s57, s57, 8192
  s_waitcnt vmcnt(5)
  buffer_load_dwordx4 v[64:67], v3, s[52:55], s57 offen nt
  s_add_u32 s57, s57, 8192
  s_waitcnt vmcnt(5)
  buffer_load_dwordx4 v[68:71], v3, s[52:55], s57 offen nt
  s_add_u32 s57, s57, 8192
  s_waitcnt vmcnt(5)
  buffer_load_dwordx4 v[72:75], v3, s[52:55], s57 offen nt
  s_add_u32 s57, s57, 8192
  s_waitcnt vmcnt(5)
  buffer_load_dwordx4 v[76:79], v3, s[52:55], s57 offen nt
  s_add_u32 s57, s57, 8192
  s_waitcnt vmcnt(5)
  buffer_load_dwordx4 v[80:83], v3, s[52:55], s57 offen nt
  s_add_u32 s57, s57, 8192
  s_waitcnt vmcnt(5)
  buffer_load_dwordx4 v[84:87], v3, s[52:55], s57 offen nt
  s_add_u32 s57, s57, 8192
  s_waitcnt vmcnt(5)
  buffer_load_dwordx4 v[88:91], v3, s[52:55], s57 offen nt
  s_add_u32 s57, s57, 8192
  s_waitcnt vmcnt(5)
  buffer_load_dwordx4 v[92:95], v3, s[52:55], s57 offen nt
  s_add_u32 s57, s57, 8192
  s_waitcnt vmcnt(5)
  buffer_load_dwordx4 v[96:99], v3, s[52:55], s57 offen nt
  s_add_u32 s57, s57, 8192
  s_waitcnt vmcnt(5)
  buffer_load_dwordx4 v[100:103], v3, s[52:55], s57 offen nt
  s_add_u32 s57, s57, 8192
  s_waitcnt vmcnt(5)
  buffer_load_dwordx4 v[104:107], v3, s[52:55], s57 offen nt
  s_add_u32 s57, s57, 8192
  s_waitcnt vmcnt(5)
  buffer_load_dwordx4 v[108:111], v3, s[52:55], s57 offen nt
  s_add_u32 s57, s57, 8192
  s_waitcnt vmcnt(5)
  buffer_load_dwordx4 v[112:115], v3, s[52:55], s57 offen nt
  s_add_u32 s57, s57, 8192
  s_waitcnt vmcnt(5)
  buffer_load_dwordx4 v[116:119], v3, s[52:55], s57 offen nt
  s_add_u32 s57, s57, 8192
  s_waitcnt vmcnt(5)
  buffer_load_dwordx4 v[120:123], v3, s[52:55], s57 offen nt
  s_add_u32 s57, s57, 8192
  s_waitcnt vmcnt(5)
  buffer_load_dwordx4 v[124:127], v3, s[52:55], s57 offen nt
  s_add_u32 s57, s57, 8192
L_w_5:
  ds_read_b32 v18, v6 offset:12
  s_waitcnt lgkmcnt(0)
  v_readfirstlane_b32 s70, v18
  s_cmp_ge_u32 s70, 64
  s_cbranch_scc1 L_wd_6
  s_sleep 1
  s_branch L_w_5
L_wd_6:
  v_mov_b32 v40, 0
  v_mov_b32 v41, 0
  v_mov_b32 v42, 0
  v_mov_b32 v43, 0
  v_mov_b32 v44, 0
  v_mov_b32 v45, 0
  v_mov_b32 v46, 0
  v_mov_b32 v47, 0
  ds_read_b128 v[48:51], v17 offset:27008
  s_waitcnt lgkmcnt(0)
  ds_read_b128 v[52:55], v17 offset:27024
  v_lshlrev_b32 v18, 16, v128
  v_and_b32 v19, 0xffff0000, v128
  v_pk_fma_f32 v[40:41], v[18:19], v[48:49], v[40:41] op_sel:[0,0,0] op_sel_hi:[1,0,1]
  v_lshlrev_b32 v36, 16, v129
  v_and_b32 v37, 0xffff0000, v129
  v_pk_fma_f32 v[42:43], v[36:37], v[48:49], v[42:43] op_sel:[0,0,0] op_sel_hi:[1,0,1]
  v_lshlrev_b32 v18, 16, v130
  v_and_b32 v19, 0xffff0000, v130
  v_pk_fma_f32 v[44:45], v[18:19], v[48:49], v[44:45] op_sel:[0,0,0] op_sel_hi:[1,0,1]
  v_lshlrev_b32 v36, 16, v131
  v_and_b32 v37, 0xffff0000, v131
  v_pk_fma_f32 v[46:47], v[36:37], v[48:49], v[46:47] op_sel:[0,0,0] op_sel_hi:[1,0,1]
  v_lshlrev_b32 v18, 16, v132
  v_and_b32 v19, 0xffff0000, v132
  v_pk_fma_f32 v[40:41], v[18:19], v[48:49], v[40:41] op_sel:[0,1,0] op_sel_hi:[1,1,1]
  v_lshlrev_b32 v36, 16, v133
  v_and_b32 v37, 0xffff0000, v133
  v_pk_fma_f32 v[42:43], v[36:37], v[48:49], v[42:43] op_sel:[0,1,0] op_sel_hi:[1,1,1]
  v_lshlrev_b32 v18, 16, v134
  v_and_b32 v19, 0xffff0000, v134
  v_pk_fma_f32 v[44:45], v[18:19], v[48:49], v[44:45] op_sel:[0,1,0] op_sel_hi:[1,1,1]
  v_lshlrev_b32 v36, 16, v135
  v_and_b32 v37, 0xffff0000, v135
  v_pk_fma_f32 v[46:47], v[36:37], v[48:49], v[46:47] op_sel:[0,1,0] op_sel_hi:[1,1,1]
  v_lshlrev_b32 v18, 16, v136
  v_and_b32 v19, 0xffff0000, v136
  v_pk_fma_f32 v[40:41], v[18:19], v[50:51], v[40:41] op_sel:[0,0,0] op_sel_hi:[1,0,1]
  v_lshlrev_b32 v36, 16, v137
  v_and_b32 v37, 0xffff0000, v137
  v_pk_fma_f32 v[42:43], v[36:37], v[50:51], v[42:43] op_sel:[0,0,0] op_sel_hi:[1,0,1]
  v_lshlrev_b32 v18, 16, v138
  v_and_b32 v19, 0xffff0000, v138
  v_pk_fma_f32 v[44:45], v[18:19], v[50:51], v[44:45] op_sel:[0,0,0] op_sel_hi:[1,0,1]
  v_lshlrev_b32 v36, 16, v139
  v_and_b32 v37, 0xffff0000, v139
  v_pk_fma_f32 v[46:47], v[36:37], v[50:51], v[46:47] op_sel:[0,0,0] op_sel_hi:[1,0,1]
  v_lshlrev_b32 v18, 16, v140
  v_and_b32 v19, 0xffff0000, v140
  v_pk_fma_f32 v[40:41], v[18:19], v[50:51], v[40:41] op_sel:[0,1,0] op_sel_hi:[1,1,1]
  v_lshlrev_b32 v36, 16, v141
  v_and_b32 v37, 0xffff0000, v141
  v_pk_fma_f32 v[42:43], v[36:37], v[50:51], v[42:43] op_sel:[0,1,0] op_sel_hi:[1,1,1]
  v_lshlrev_b32 v18, 16, v142
  v_and_b32 v19, 0xffff0000, v142
  v_pk_fma_f32 v[44:45], v[18:19], v[50:51], v[44:45] op_sel:[0,1,0] op_sel_hi:[1,1,1]
  v_lshlrev_b32 v36, 16, v143
  v_and_b32 v37, 0xffff0000, v143
  v_pk_fma_f32 v[46:47], v[36:37], v[50:51], v[46:47] op_sel:[0,1,0] op_sel_hi:[1,1,1]
  s_waitcnt vmcnt(5)
  buffer_load_dwordx4 v[128:131], v3, s[52:55], s57 offen nt
  s_add_u32 s57, s57, 8192
  s_waitcnt lgkmcnt(0)
  ds_read_b128 v[48:51], v17 offset:27040
  v_lshlrev_b32 v18, 16, v144
  v_and_b32 v19, 0xffff0000, v144
  v_pk_fma_f32 v[40:41], v[18:19], v[52:53], v[40:41] op_sel:[0,0,0] op_sel_hi:[1,0,1]
  v_lshlrev_b32 v36, 16, v145
  v_and_b32 v37, 0xffff0000, v145
  v_pk_fma_f32 v[42:43], v[36:37], v[52:53], v[42:43] op_sel:[0,0,0] op_sel_hi:[1,0,1]
  v_lshlrev_b32 v18, 16, v146
  v_and_b32 v19, 0xffff0000, v146
  v_pk_fma_f32 v[44:45], v[18:19], v[52:53], v[44:45] op_sel:[0,0,0] op_sel_hi:[1,0,1]
  v_lshlrev_b32 v36, 16, v147
  v_and_b32 v37, 0xffff0000, v147
  v_pk_fma_f32 v[46:47], v[36:37], v[52:53], v[46:47] op_sel:[0,0,0] op_sel_hi:[1,0,1]
  v_lshlrev_b32 v18, 16, v148
  v_and_b32 v19, 0xffff0000, v148
  v_pk_fma_f32 v[40:41], v[18:19], v[52:53], v[40:41] op_sel:[0,1,0] op_sel_hi:[1,1,1]
  v_lshlrev_b32 v36, 16, v149
  v_and_b32 v37, 0xffff0000, v149
  v_pk_fma_f32 v[42:43], v[36:37], v[52:53], v[42:43] op_sel:[0,1,0] op_sel_hi:[1,1,1]
  v_lshlrev_b32 v18, 16, v150
  v_and_b32 v19, 0xffff0000, v150
  v_pk_fma_f32 v[44:45], v[18:19], v[52:53], v[44:45] op_sel:[0,1,0] op_sel_hi:[1,1,1]
  v_lshlrev_b32 v36, 16, v151
  v_and_b32 v37, 0xffff0000, v151
  v_pk_fma_f32 v[46:47], v[36:37], v[52:53], v[46:47] op_sel:[0,1,0] op_sel_hi:[1,1,1]
  v_lshlrev_b32 v18, 16, v152
  v_and_b32 v19, 0xffff0000, v152
  v_pk_fma_f32 v[40:41], v[18:19], v[54:55], v[40:41] op_sel:[0,0,0] op_sel_hi:[1,0,1]
  v_lshlrev_b32 v36, 16, v153
  v_and_b32 v37, 0xffff0000, v153
  v_pk_fma_f32 v[42:43], v[36:37], v[54:55], v[42:43] op_sel:[0,0,0] op_sel_hi:[1,0,1]
  v_lshlrev_b32 v18, 16, v154
  v_and_b32 v19, 0xffff0000, v154
  v_pk_fma_f32 v[44:45], v[18:19], v[54:55], v[44:45] op_sel:[0,0,0] op_sel_hi:[1,0,1]
  v_lshlrev_b32 v36, 16, v155
  v_and_b32 v37, 0xffff0000, v155
  v_pk_fma_f32 v[46:47], v[36:37], v[54:55], v[46:47] op_sel:[0,0,0] op_sel_hi:[1,0,1]
  v_lshlrev_b32 v18, 16, v156
  v_and_b32 v19, 0xffff0000, v156
  v_pk_fma_f32 v[40:41], v[18:19], v[54:55], v[40:41] op_sel:[0,1,0] op_sel_hi:[1,1,1]
  v_lshlrev_b32 v36, 16, v157
  v_and_b32 v37, 0xffff0000, v157
  v_pk_fma_f32 v[42:43], v[36:37], v[54:55], v[42:43] op_sel:[0,1,0] op_sel_hi:[1,1,1]
  v_lshlrev_b32 v18, 16, v158
  v_and_b32 v19, 0xffff0000, v158
  v_pk_fma_f32 v[44:45], v[18:19], v[54:55], v[44:45] op_sel:[0,1,0] op_sel_hi:[1,1,1]
  v_lshlrev_b32 v36, 16, v159
  v_and_b32 v37, 0xffff0000, v159
  v_pk_fma_f32 v[46:47], v[36:37], v[54:55], v[46:47] op_sel:[0,1,0] op_sel_hi:[1,1,1]
  s_waitcnt vmcnt(5)
  buffer_load_dwordx4 v[132:135], v3, s[52:55], s57 offen nt
  s_add_u32 s57, s57, 8192
  s_waitcnt lgkmcnt(0)
  ds_read_b128 v[52:55], v17 offset:27056
  v_lshlrev_b32 v18, 16, v160
  v_and_b32 v19, 0xffff0000, v160
  v_pk_fma_f32 v[40:41], v[18:19], v[48:49], v[40:41] op_sel:[0,0,0] op_sel_hi:[1,0,1]
  v_lshlrev_b32 v36, 16, v161
  v_and_b32 v37, 0xffff0000, v161
  v_pk_fma_f32 v[42:43], v[36:37], v[48:49], v[42:43] op_sel:[0,0,0] op_sel_hi:[1,0,1]
  v_lshlrev_b32 v18, 16, v162
  v_and_b32 v19, 0xffff0000, v162
  v_pk_fma_f32 v[44:45], v[18:19], v[48:49], v[44:45] op_sel:[0,0,0] op_sel_hi:[1,0,1]
  v_lshlrev_b32 v36, 16, v163
  v_and_b32 v37, 0xffff0000, v163
  v_pk_fma_f32 v[46:47], v[36:37], v[48:49], v[46:47] op_sel:[0,0,0] op_sel_hi:[1,0,1]
  v_lshlrev_b32 v18, 16, v164
  v_and_b32 v19, 0xffff0000, v164
  v_pk_fma_f32 v[40:41], v[18:19], v[48:49], v[40:41] op_sel:[0,1,0] op_sel_hi:[1,1,1]
  v_lshlrev_b32 v36, 16, v165
  v_and_b32 v37, 0xffff0000, v165
  v_pk_fma_f32 v[42:43], v[36:37], v[48:49], v[42:43] op_sel:[0,1,0] op_sel_hi:[1,1,1]
  v_lshlrev_b32 v18, 16, v166
  v_and_b32 v19, 0xffff0000, v166
  v_pk_fma_f32 v[44:45], v[18:19], v[48:49], v[44:45] op_sel:[0,1,0] op_sel_hi:[1,1,1]
  v_lshlrev_b32 v36, 16, v167
  v_and_b32 v37, 0xffff0000, v167
  v_pk_fma_f32 v[46:47], v[36:37], v[48:49], v[46:47] op_sel:[0,1,0] op_sel_hi:[1,1,1]
  v_lshlrev_b32 v18, 16, v168
  v_and_b32 v19, 0xffff0000, v168
  v_pk_fma_f32 v[40:41], v[18:19], v[50:51], v[40:41] op_sel:[0,0,0] op_sel_hi:[1,0,1]
  v_lshlrev_b32 v36, 16, v169
  v_and_b32 v37, 0xffff0000, v169
  v_pk_fma_f32 v[42:43], v[36:37], v[50:51], v[42:43] op_sel:[0,0,0] op_sel_hi:[1,0,1]
  v_lshlrev_b32 v18, 16, v170
  v_and_b32 v19, 0xffff0000, v170
  v_pk_fma_f32 v[44:45], v[18:19], v[50:51], v[44:45] op_sel:[0,0,0] op_sel_hi:[1,0,1]
  v_lshlrev_b32 v36, 16, v171
  v_and_b32 v37, 0xffff0000, v171
  v_pk_fma_f32 v[46:47], v[36:37], v[50:51], v[46:47] op_sel:[0,0,0] op_sel_hi:[1,0,1]
  v_lshlrev_b32 v18, 16, v172
  v_and_b32 v19, 0xffff0000, v172
  v_pk_fma_f32 v[40:41], v[18:19], v[50:51], v[40:41] op_sel:[0,1,0] op_sel_hi:[1,1,1]
  v_lshlrev_b32 v36, 16, v173
  v_and_b32 v37, 0xffff0000, v173
  v_pk_fma_f32 v[42:43], v[36:37], v[50:51], v[42:43] op_sel:[0,1,0] op_sel_hi:[1,1,1]
  v_lshlrev_b32 v18, 16, v174
  v_and_b32 v19, 0xffff0000, v174
  v_pk_fma_f32 v[44:45], v[18:19], v[50:51], v[44:45] op_sel:[0,1,0] op_sel_hi:[1,1,1]
  v_lshlrev_b32 v36, 16, v175
  v_and_b32 v37, 0xffff0000, v175
  v_pk_fma_f32 v[46:47], v[36:37], v[50:51], v[46:47] op_sel:[0,1,0] op_sel_hi:[1,1,1]
  s_waitcnt vmcnt(5)
  buffer_load_dwordx4 v[136:139], v3, s[52:55], s57 offen nt
  s_add_u32 s57, s57, 8192
  s_waitcnt lgkmcnt(0)
  ds_read_b128 v[48:51], v17 offset:27072
  v_lshlrev_b32 v18, 16, v176
  v_and_b32 v19, 0xffff0000, v176
  v_pk_fma_f32 v[40:41], v[18:19], v[52:53], v[40:41] op_sel:[0,0,0] op_sel_hi:[1,0,1]
  v_lshlrev_b32 v36, 16, v177
  v_and_b32 v37, 0xffff0000, v177
  v_pk_fma_f32 v[42:43], v[36:37], v[52:53], v[42:43] op_sel:[0,0,0] op_sel_hi:[1,0,1]
  v_lshlrev_b32 v18, 16, v178
  v_and_b32 v19, 0xffff0000, v178
  v_pk_fma_f32 v[44:45], v[18:19], v[52:53], v[44:45] op_sel:[0,0,0] op_sel_hi:[1,0,1]
  v_lshlrev_b32 v36, 16, v179
  v_and_b32 v37, 0xffff0000, v179
  v_pk_fma_f32 v[46:47], v[36:37], v[52:53], v[46:47] op_sel:[0,0,0] op_sel_hi:[1,0,1]
  v_lshlrev_b32 v18, 16, v180
  v_and_b32 v19, 0xffff0000, v180
  v_pk_fma_f32 v[40:41], v[18:19], v[52:53], v[40:41] op_sel:[0,1,0] op_sel_hi:[1,1,1]
  v_lshlrev_b32 v36, 16, v181
  v_and_b32 v37, 0xffff0000, v181
  v_pk_fma_f32 v[42:43], v[36:37], v[52:53], v[42:43] op_sel:[0,1,0] op_sel_hi:[1,1,1]
  v_lshlrev_b32 v18, 16, v182
  v_and_b32 v19, 0xffff0000, v182
  v_pk_fma_f32 v[44:45], v[18:19], v[52:53], v[44:45] op_sel:[0,1,0] op_sel_hi:[1,1,1]
  v_lshlrev_b32 v36, 16, v183
  v_and_b32 v37, 0xffff0000, v183
  v_pk_fma_f32 v[46:47], v[36:37], v[52:53], v[46:47] op_sel:[0,1,0] op_sel_hi:[1,1,1]
  v_lshlrev_b32 v18, 16, v184
  v_and_b32 v19, 0xffff0000, v184
  v_pk_fma_f32 v[40:41], v[18:19], v[54:55], v[40:41] op_sel:[0,0,0] op_sel_hi:[1,0,1]
  v_lshlrev_b32 v36, 16, v185
  v_and_b32 v37, 0xffff0000, v185
  v_pk_fma_f32 v[42:43], v[36:37], v[54:55], v[42:43] op_sel:[0,0,0] op_sel_hi:[1,0,1]
  v_lshlrev_b32 v18, 16, v186
  v_and_b32 v19, 0xffff0000, v186
  v_pk_fma_f32 v[44:45], v[18:19], v[54:55], v[44:45] op_sel:[0,0,0] op_sel_hi:[1,0,1]
  v_lshlrev_b32 v36, 16, v187
  v_and_b32 v37, 0xffff0000, v187
  v_pk_fma_f32 v[46:47], v[36:37], v[54:55], v[46:47] op_sel:[0,0,0] op_sel_hi:[1,0,1]
  v_lshlrev_b32 v18, 16, v188
  v_and_b32 v19, 0xffff0000, v188
  v_pk_fma_f32 v[40:41], v[18:19], v[54:55], v[40:41] op_sel:[0,1,0] op_sel_hi:[1,1,1]
  v_lshlrev_b32 v36, 16, v189
  v_and_b32 v37, 0xffff0000, v189
  v_pk_fma_f32 v[42:43], v[36:37], v[54:55], v[42:43] op_sel:[0,1,0] op_sel_hi:[1,1,1]
  v_lshlrev_b32 v18, 16, v190
  v_and_b32 v19, 0xffff0000, v190
  v_pk_fma_f32 v[44:45], v[18:19], v[54:55], v[44:45] op_sel:[0,1,0] op_sel_hi:[1,1,1]
  v_lshlrev_b32 v36, 16, v191
  v_and_b32 v37, 0xffff0000, v191
  v_pk_fma_f32 v[46:47], v[36:37], v[54:55], v[46:47] op_sel:[0,1,0] op_sel_hi:[1,1,1]
  s_waitcnt vmcnt(5)
  buffer_load_dwordx4 v[140:143], v3, s[52:55], s57 offen nt
  s_add_u32 s57, s57, 8192
  s_waitcnt lgkmcnt(0)
  ds_read_b128 v[52:55], v17 offset:27088
  v_lshlrev_b32 v18, 16, v192
  v_and_b32 v19, 0xffff0000, v192
  v_pk_fma_f32 v[40:41], v[18:19], v[48:49], v[40:41] op_sel:[0,0,0] op_sel_hi:[1,0,1]
  v_lshlrev_b32 v36, 16, v193
  v_and_b32 v37, 0xffff0000, v193
  v_pk_fma_f32 v[42:43], v[36:37], v[48:49], v[42:43] op_sel:[0,0,0] op_sel_hi:[1,0,1]
  v_lshlrev_b32 v18, 16, v194
  v_and_b32 v19, 0xffff0000, v194
  v_pk_fma_f32 v[44:45], v[18:19], v[48:49], v[44:45] op_sel:[0,0,0] op_sel_hi:[1,0,1]
  v_lshlrev_b32 v36, 16, v195
  v_and_b32 v37, 0xffff0000, v195
  v_pk_fma_f32 v[46:47], v[36:37], v[48:49], v[46:47] op_sel:[0,0,0] op_sel_hi:[1,0,1]
  v_lshlrev_b32 v18, 16, v196
  v_and_b32 v19, 0xffff0000, v196
  v_pk_fma_f32 v[40:41], v[18:19], v[48:49], v[40:41] op_sel:[0,1,0] op_sel_hi:[1,1,1]
  v_lshlrev_b32 v36, 16, v197
  v_and_b32 v37, 0xffff0000, v197
  v_pk_fma_f32 v[42:43], v[36:37], v[48:49], v[42:43] op_sel:[0,1,0] op_sel_hi:[1,1,1]
  v_lshlrev_b32 v18, 16, v198
  v_and_b32 v19, 0xffff0000, v198
  v_pk_fma_f32 v[44:45], v[18:19], v[48:49], v[44:45] op_sel:[0,1,0] op_sel_hi:[1,1,1]
  v_lshlrev_b32 v36, 16, v199
  v_and_b32 v37, 0xffff0000, v199
  v_pk_fma_f32 v[46:47], v[36:37], v[48:49], v[46:47] op_sel:[0,1,0] op_sel_hi:[1,1,1]
  v_lshlrev_b32 v18, 16, v200
  v_and_b32 v19, 0xffff0000, v200
  v_pk_fma_f32 v[40:41], v[18:19], v[50:51], v[40:41] op_sel:[0,0,0] op_sel_hi:[1,0,1]
  v_lshlrev_b32 v36, 16, v201
  v_and_b32 v37, 0xffff0000, v201
  v_pk_fma_f32 v[42:43], v[36:37], v[50:51], v[42:43] op_sel:[0,0,0] op_sel_hi:[1,0,1]
  v_lshlrev_b32 v18, 16, v202
  v_and_b32 v19, 0xffff0000, v202
  v_pk_fma_f32 v[44:45], v[18:19], v[50:51], v[44:45] op_sel:[0,0,0] op_sel_hi:[1,0,1]
  v_lshlrev_b32 v36, 16, v203
  v_and_b32 v37, 0xffff0000, v203
  v_pk_fma_f32 v[46:47], v[36:37], v[50:51], v[46:47] op_sel:[0,0,0] op_sel_hi:[1,0,1]
  v_lshlrev_b32 v18, 16, v204
  v_and_b32 v19, 0xffff0000, v204
  v_pk_fma_f32 v[40:41], v[18:19], v[50:51], v[40:41] op_sel:[0,1,0] op_sel_hi:[1,1,1]
  v_lshlrev_b32 v36, 16, v205
  v_and_b32 v37, 0xffff0000, v205
  v_pk_fma_f32 v[42:43], v[36:37], v[50:51], v[42:43] op_sel:[0,1,0] op_sel_hi:[1,1,1]
  v_lshlrev_b32 v18, 16, v206
  v_and_b32 v19, 0xffff0000, v206
  v_pk_fma_f32 v[44:45], v[18:19], v[50:51], v[44:45] op_sel:[0,1,0] op_sel_hi:[1,1,1]
  v_lshlrev_b32 v36, 16, v207
  v_and_b32 v37, 0xffff0000, v207
  v_pk_fma_f32 v[46:47], v[36:37], v[50:51], v[46:47] op_sel:[0,1,0] op_sel_hi:[1,1,1]
  s_waitcnt vmcnt(5)
  buffer_load_dwordx4 v[144:147], v3, s[52:55], s57 offen nt
  s_add_u32 s57, s57, 8192
  s_waitcnt lgkmcnt(0)
  ds_read_b128 v[48:51], v17 offset:27104
  v_lshlrev_b32 v18, 16, v208
  v_and_b32 v19, 0xffff0000, v208
  v_pk_fma_f32 v[40:41], v[18:19], v[52:53], v[40:41] op_sel:[0,0,0] op_sel_hi:[1,0,1]
  v_lshlrev_b32 v36, 16, v209
  v_and_b32 v37, 0xffff0000, v209
  v_pk_fma_f32 v[42:43], v[36:37], v[52:53], v[42:43] op_sel:[0,0,0] op_sel_hi:[1,0,1]
  v_lshlrev_b32 v18, 16, v210
  v_and_b32 v19, 0xffff0000, v210
  v_pk_fma_f32 v[44:45], v[18:19], v[52:53], v[44:45] op_sel:[0,0,0] op_sel_hi:[1,0,1]
  v_lshlrev_b32 v36, 16, v211
  v_and_b32 v37, 0xffff0000, v211
  v_pk_fma_f32 v[46:47], v[36:37], v[52:53], v[46:47] op_sel:[0,0,0] op_sel_hi:[1,0,1]
  v_lshlrev_b32 v18, 16, v212
  v_and_b32 v19, 0xffff0000, v212
  v_pk_fma_f32 v[40:41], v[18:19], v[52:53], v[40:41] op_sel:[0,1,0] op_sel_hi:[1,1,1]
  v_lshlrev_b32 v36, 16, v213
  v_and_b32 v37, 0xffff0000, v213
  v_pk_fma_f32 v[42:43], v[36:37], v[52:53], v[42:43] op_sel:[0,1,0] op_sel_hi:[1,1,1]
  v_lshlrev_b32 v18, 16, v214
  v_and_b32 v19, 0xffff0000, v214
  v_pk_fma_f32 v[44:45], v[18:19], v[52:53], v[44:45] op_sel:[0,1,0] op_sel_hi:[1,1,1]
  v_lshlrev_b32 v36, 16, v215
  v_and_b32 v37, 0xffff0000, v215
  v_pk_fma_f32 v[46:47], v[36:37], v[52:53], v[46:47] op_sel:[0,1,0] op_sel_hi:[1,1,1]
  v_lshlrev_b32 v18, 16, v216
  v_and_b32 v19, 0xffff0000, v216
  v_pk_fma_f32 v[40:41], v[18:19], v[54:55], v[40:41] op_sel:[0,0,0] op_sel_hi:[1,0,1]
  v_lshlrev_b32 v36, 16, v217
  v_and_b32 v37, 0xffff0000, v217
  v_pk_fma_f32 v[42:43], v[36:37], v[54:55], v[42:43] op_sel:[0,0,0] op_sel_hi:[1,0,1]
  v_lshlrev_b32 v18, 16, v218
  v_and_b32 v19, 0xffff0000, v218
  v_pk_fma_f32 v[44:45], v[18:19], v[54:55], v[44:45] op_sel:[0,0,0] op_sel_hi:[1,0,1]
  v_lshlrev_b32 v36, 16, v219
  v_and_b32 v37, 0xffff0000, v219
  v_pk_fma_f32 v[46:47], v[36:37], v[54:55], v[46:47] op_sel:[0,0,0] op_sel_hi:[1,0,1]
  v_lshlrev_b32 v18, 16, v220
  v_and_b32 v19, 0xffff0000, v220
  v_pk_fma_f32 v[40:41], v[18:19], v[54:55], v[40:41] op_sel:[0,1,0] op_sel_hi:[1,1,1]
  v_lshlrev_b32 v36, 16, v221
  v_and_b32 v37, 0xffff0000, v221
  v_pk_fma_f32 v[42:43], v[36:37], v[54:55], v[42:43] op_sel:[0,1,0] op_sel_hi:[1,1,1]
  v_lshlrev_b32 v18, 16, v222
  v_and_b32 v19, 0xffff0000, v222
  v_pk_fma_f32 v[44:45], v[18:19], v[54:55], v[44:45] op_sel:[0,1,0] op_sel_hi:[1,1,1]
  v_lshlrev_b32 v36, 16, v223
  v_and_b32 v37, 0xffff0000, v223
  v_pk_fma_f32 v[46:47], v[36:37], v[54:55], v[46:47] op_sel:[0,1,0] op_sel_hi:[1,1,1]
  s_waitcnt vmcnt(5)
  buffer_load_dwordx4 v[148:151], v3, s[52:55], s57 offen nt
  s_add_u32 s57, s57, 8192
  s_waitcnt lgkmcnt(0)
  ds_read_b128 v[52:55], v17 offset:27120
  v_lshlrev_b32 v18, 16, v224
  v_and_b32 v19, 0xffff0000, v224
  v_pk_fma_f32 v[40:41], v[18:19], v[48:49], v[40:41] op_sel:[0,0,0] op_sel_hi:[1,0,1]
  v_lshlrev_b32 v36, 16, v225
  v_and_b32 v37, 0xffff0000, v225
  v_pk_fma_f32 v[42:43], v[36:37], v[48:49], v[42:43] op_sel:[0,0,0] op_sel_hi:[1,0,1]
  v_lshlrev_b32 v18, 16, v226
  v_and_b32 v19, 0xffff0000, v226
  v_pk_fma_f32 v[44:45], v[18:19], v[48:49], v[44:45] op_sel:[0,0,0] op_sel_hi:[1,0,1]
  v_lshlrev_b32 v36, 16, v227
  v_and_b32 v37, 0xffff0000, v227
  v_pk_fma_f32 v[46:47], v[36:37], v[48:49], v[46:47] op_sel:[0,0,0] op_sel_hi:[1,0,1]
  v_lshlrev_b32 v18, 16, v228
  v_and_b32 v19, 0xffff0000, v228
  v_pk_fma_f32 v[40:41], v[18:19], v[48:49], v[40:41] op_sel:[0,1,0] op_sel_hi:[1,1,1]
  v_lshlrev_b32 v36, 16, v229
  v_and_b32 v37, 0xffff0000, v229
  v_pk_fma_f32 v[42:43], v[36:37], v[48:49], v[42:43] op_sel:[0,1,0] op_sel_hi:[1,1,1]
  v_lshlrev_b32 v18, 16, v230
  v_and_b32 v19, 0xffff0000, v230
  v_pk_fma_f32 v[44:45], v[18:19], v[48:49], v[44:45] op_sel:[0,1,0] op_sel_hi:[1,1,1]
  v_lshlrev_b32 v36, 16, v231
  v_and_b32 v37, 0xffff0000, v231
  v_pk_fma_f32 v[46:47], v[36:37], v[48:49], v[46:47] op_sel:[0,1,0] op_sel_hi:[1,1,1]
  v_lshlrev_b32 v18, 16, v232
  v_and_b32 v19, 0xffff0000, v232
  v_pk_fma_f32 v[40:41], v[18:19], v[50:51], v[40:41] op_sel:[0,0,0] op_sel_hi:[1,0,1]
  v_lshlrev_b32 v36, 16, v233
  v_and_b32 v37, 0xffff0000, v233
  v_pk_fma_f32 v[42:43], v[36:37], v[50:51], v[42:43] op_sel:[0,0,0] op_sel_hi:[1,0,1]
  v_lshlrev_b32 v18, 16, v234
  v_and_b32 v19, 0xffff0000, v234
  v_pk_fma_f32 v[44:45], v[18:19], v[50:51], v[44:45] op_sel:[0,0,0] op_sel_hi:[1,0,1]
  v_lshlrev_b32 v36, 16, v235
  v_and_b32 v37, 0xffff0000, v235
  v_pk_fma_f32 v[46:47], v[36:37], v[50:51], v[46:47] op_sel:[0,0,0] op_sel_hi:[1,0,1]
  v_lshlrev_b32 v18, 16, v236
  v_and_b32 v19, 0xffff0000, v236
  v_pk_fma_f32 v[40:41], v[18:19], v[50:51], v[40:41] op_sel:[0,1,0] op_sel_hi:[1,1,1]
  v_lshlrev_b32 v36, 16, v237
  v_and_b32 v37, 0xffff0000, v237
  v_pk_fma_f32 v[42:43], v[36:37], v[50:51], v[42:43] op_sel:[0,1,0] op_sel_hi:[1,1,1]
  v_lshlrev_b32 v18, 16, v238
  v_and_b32 v19, 0xffff0000, v238
  v_pk_fma_f32 v[44:45], v[18:19], v[50:51], v[44:45] op_sel:[0,1,0] op_sel_hi:[1,1,1]
  v_lshlrev_b32 v36, 16, v239
  v_and_b32 v37, 0xffff0000, v239
  v_pk_fma_f32 v[46:47], v[36:37], v[50:51], v[46:47] op_sel:[0,1,0] op_sel_hi:[1,1,1]
  s_waitcnt vmcnt(5)
  buffer_load_dwordx4 v[152:155], v3, s[52:55], s57 offen nt
  s_add_u32 s57, s57, 8192
  s_waitcnt lgkmcnt(0)
  ds_read_b128 v[48:51], v17 offset:27136
  v_lshlrev_b32 v18, 16, v240
  v_and_b32 v19, 0xffff0000, v240
  v_pk_fma_f32 v[40:41], v[18:19], v[52:53], v[40:41] op_sel:[0,0,0] op_sel_hi:[1,0,1]
  v_lshlrev_b32 v36, 16, v241
  v_and_b32 v37, 0xffff0000, v241
  v_pk_fma_f32 v[42:43], v[36:37], v[52:53], v[42:43] op_sel:[0,0,0] op_sel_hi:[1,0,1]
  v_lshlrev_b32 v18, 16, v242
  v_and_b32 v19, 0xffff0000, v242
  v_pk_fma_f32 v[44:45], v[18:19], v[52:53], v[44:45] op_sel:[0,0,0] op_sel_hi:[1,0,1]
  v_lshlrev_b32 v36, 16, v243
  v_and_b32 v37, 0xffff0000, v243
  v_pk_fma_f32 v[46:47], v[36:37], v[52:53], v[46:47] op_sel:[0,0,0] op_sel_hi:[1,0,1]
  v_lshlrev_b32 v18, 16, v244
  v_and_b32 v19, 0xffff0000, v244
  v_pk_fma_f32 v[40:41], v[18:19], v[52:53], v[40:41] op_sel:[0,1,0] op_sel_hi:[1,1,1]
  v_lshlrev_b32 v36, 16, v245
  v_and_b32 v37, 0xffff0000, v245
  v_pk_fma_f32 v[42:43], v[36:37], v[52:53], v[42:43] op_sel:[0,1,0] op_sel_hi:[1,1,1]
  v_lshlrev_b32 v18, 16, v246
  v_and_b32 v19, 0xffff0000, v246
  v_pk_fma_f32 v[44:45], v[18:19], v[52:53], v[44:45] op_sel:[0,1,0] op_sel_hi:[1,1,1]
  v_lshlrev_b32 v36, 16, v247
  v_and_b32 v37, 0xffff0000, v247
  v_pk_fma_f32 v[46:47], v[36:37], v[52:53], v[46:47] op_sel:[0,1,0] op_sel_hi:[1,1,1]
  v_lshlrev_b32 v18, 16, v248
  v_and_b32 v19, 0xffff0000, v248
  v_pk_fma_f32 v[40:41], v[18:19], v[54:55], v[40:41] op_sel:[0,0,0] op_sel_hi:[1,0,1]
  v_lshlrev_b32 v36, 16, v249
  v_and_b32 v37, 0xffff0000, v249
  v_pk_fma_f32 v[42:43], v[36:37], v[54:55], v[42:43] op_sel:[0,0,0] op_sel_hi:[1,0,1]
  v_lshlrev_b32 v18, 16, v250
  v_and_b32 v19, 0xffff0000, v250
  v_pk_fma_f32 v[44:45], v[18:19], v[54:55], v[44:45] op_sel:[0,0,0] op_sel_hi:[1,0,1]
  v_lshlrev_b32 v36, 16, v251
  v_and_b32 v37, 0xffff0000, v251
  v_pk_fma_f32 v[46:47], v[36:37], v[54:55], v[46:47] op_sel:[0,0,0] op_sel_hi:[1,0,1]
  v_lshlrev_b32 v18, 16, v252
  v_and_b32 v19, 0xffff0000, v252
  v_pk_fma_f32 v[40:41], v[18:19], v[54:55], v[40:41] op_sel:[0,1,0] op_sel_hi:[1,1,1]
  v_lshlrev_b32 v36, 16, v253
  v_and_b32 v37, 0xffff0000, v253
  v_pk_fma_f32 v[42:43], v[36:37], v[54:55], v[42:43] op_sel:[0,1,0] op_sel_hi:[1,1,1]
  v_lshlrev_b32 v18, 16, v254
  v_and_b32 v19, 0xffff0000, v254
  v_pk_fma_f32 v[44:45], v[18:19], v[54:55], v[44:45] op_sel:[0,1,0] op_sel_hi:[1,1,1]
  v_lshlrev_b32 v36, 16, v255
  v_and_b32 v37, 0xffff0000, v255
  v_pk_fma_f32 v[46:47], v[36:37], v[54:55], v[46:47] op_sel:[0,1,0] op_sel_hi:[1,1,1]
  s_waitcnt vmcnt(5)
  buffer_load_dwordx4 v[156:159], v3, s[52:55], s57 offen nt
  s_add_u32 s57, s57, 8192
  s_waitcnt lgkmcnt(0)
  ds_read_b128 v[52:55], v17 offset:27152
  v_lshlrev_b32 v18, 16, v64
  v_and_b32 v19, 0xffff0000, v64
  v_pk_fma_f32 v[40:41], v[18:19], v[48:49], v[40:41] op_sel:[0,0,0] op_sel_hi:[1,0,1]
  v_lshlrev_b32 v36, 16, v65
  v_and_b32 v37, 0xffff0000, v65
  v_pk_fma_f32 v[42:43], v[36:37], v[48:49], v[42:43] op_sel:[0,0,0] op_sel_hi:[1,0,1]
  v_lshlrev_b32 v18, 16, v66
  v_and_b32 v19, 0xffff0000, v66
  v_pk_fma_f32 v[44:45], v[18:19], v[48:49], v[44:45] op_sel:[0,0,0] op_sel_hi:[1,0,1]
  v_lshlrev_b32 v36, 16, v67
  v_and_b32 v37, 0xffff0000, v67
  v_pk_fma_f32 v[46:47], v[36:37], v[48:49], v[46:47] op_sel:[0,0,0] op_sel_hi:[1,0,1]
  v_lshlrev_b32 v18, 16, v68
  v_and_b32 v19, 0xffff0000, v68
  v_pk_fma_f32 v[40:41], v[18:19], v[48:49], v[40:41] op_sel:[0,1,0] op_sel_hi:[1,1,1]
  v_lshlrev_b32 v36, 16, v69
  v_and_b32 v37, 0xffff0000, v69
  v_pk_fma_f32 v[42:43], v[36:37], v[48:49], v[42:43] op_sel:[0,1,0] op_sel_hi:[1,1,1]
  v_lshlrev_b32 v18, 16, v70
  v_and_b32 v19, 0xffff0000, v70
  v_pk_fma_f32 v[44:45], v[18:19], v[48:49], v[44:45] op_sel:[0,1,0] op_sel_hi:[1,1,1]
  v_lshlrev_b32 v36, 16, v71
  v_and_b32 v37, 0xffff0000, v71
  v_pk_fma_f32 v[46:47], v[36:37], v[48:49], v[46:47] op_sel:[0,1,0] op_sel_hi:[1,1,1]
  v_lshlrev_b32 v18, 16, v72
  v_and_b32 v19, 0xffff0000, v72
  v_pk_fma_f32 v[40:41], v[18:19], v[50:51], v[40:41] op_sel:[0,0,0] op_sel_hi:[1,0,1]
  v_lshlrev_b32 v36, 16, v73
  v_and_b32 v37, 0xffff0000, v73
  v_pk_fma_f32 v[42:43], v[36:37], v[50:51], v[42:43] op_sel:[0,0,0] op_sel_hi:[1,0,1]
  v_lshlrev_b32 v18, 16, v74
  v_and_b32 v19, 0xffff0000, v74
  v_pk_fma_f32 v[44:45], v[18:19], v[50:51], v[44:45] op_sel:[0,0,0] op_sel_hi:[1,0,1]
  v_lshlrev_b32 v36, 16, v75
  v_and_b32 v37, 0xffff0000, v75
  v_pk_fma_f32 v[46:47], v[36:37], v[50:51], v[46:47] op_sel:[0,0,0] op_sel_hi:[1,0,1]
  v_lshlrev_b32 v18, 16, v76
  v_and_b32 v19, 0xffff0000, v76
  v_pk_fma_f32 v[40:41], v[18:19], v[50:51], v[40:41] op_sel:[0,1,0] op_sel_hi:[1,1,1]
  v_lshlrev_b32 v36, 16, v77
  v_and_b32 v37, 0xffff0000, v77
  v_pk_fma_f32 v[42:43], v[36:37], v[50:51], v[42:43] op_sel:[0,1,0] op_sel_hi:[1,1,1]
  v_lshlrev_b32 v18, 16, v78
  v_and_b32 v19, 0xffff0000, v78
  v_pk_fma_f32 v[44:45], v[18:19], v[50:51], v[44:45] op_sel:[0,1,0] op_sel_hi:[1,1,1]
  v_lshlrev_b32 v36, 16, v79
  v_and_b32 v37, 0xffff0000, v79
  v_pk_fma_f32 v[46:47], v[36:37], v[50:51], v[46:47] op_sel:[0,1,0] op_sel_hi:[1,1,1]
  s_waitcnt vmcnt(5)
  buffer_load_dwordx4 v[160:163], v3, s[52:55], s57 offen nt
  s_add_u32 s57, s57, 8192
  s_waitcnt lgkmcnt(0)
  ds_read_b128 v[48:51], v17 offset:27168
  v_lshlrev_b32 v18, 16, v80
  v_and_b32 v19, 0xffff0000, v80
  v_pk_fma_f32 v[40:41], v[18:19], v[52:53], v[40:41] op_sel:[0,0,0] op_sel_hi:[1,0,1]
  v_lshlrev_b32 v36, 16, v81
  v_and_b32 v37, 0xffff0000, v81
  v_pk_fma_f32 v[42:43], v[36:37], v[52:53], v[42:43] op_sel:[0,0,0] op_sel_hi:[1,0,1]
  v_lshlrev_b32 v18, 16, v82
  v_and_b32 v19, 0xffff0000, v82
  v_pk_fma_f32 v[44:45], v[18:19], v[52:53], v[44:45] op_sel:[0,0,0] op_sel_hi:[1,0,1]
  v_lshlrev_b32 v36, 16, v83
  v_and_b32 v37, 0xffff0000, v83
  v_pk_fma_f32 v[46:47], v[36:37], v[52:53], v[46:47] op_sel:[0,0,0] op_sel_hi:[1,0,1]
  v_lshlrev_b32 v18, 16, v84
  v_and_b32 v19, 0xffff0000, v84
  v_pk_fma_f32 v[40:41], v[18:19], v[52:53], v[40:41] op_sel:[0,1,0] op_sel_hi:[1,1,1]
  v_lshlrev_b32 v36, 16, v85
  v_and_b32 v37, 0xffff0000, v85
  v_pk_fma_f32 v[42:43], v[36:37], v[52:53], v[42:43] op_sel:[0,1,0] op_sel_hi:[1,1,1]
  v_lshlrev_b32 v18, 16, v86
  v_and_b32 v19, 0xffff0000, v86
  v_pk_fma_f32 v[44:45], v[18:19], v[52:53], v[44:45] op_sel:[0,1,0] op_sel_hi:[1,1,1]
  v_lshlrev_b32 v36, 16, v87
  v_and_b32 v37, 0xffff0000, v87
  v_pk_fma_f32 v[46:47], v[36:37], v[52:53], v[46:47] op_sel:[0,1,0] op_sel_hi:[1,1,1]
  v_lshlrev_b32 v18, 16, v88
  v_and_b32 v19, 0xffff0000, v88
  v_pk_fma_f32 v[40:41], v[18:19], v[54:55], v[40:41] op_sel:[0,0,0] op_sel_hi:[1,0,1]
  v_lshlrev_b32 v36, 16, v89
  v_and_b32 v37, 0xffff0000, v89
  v_pk_fma_f32 v[42:43], v[36:37], v[54:55], v[42:43] op_sel:[0,0,0] op_sel_hi:[1,0,1]
  v_lshlrev_b32 v18, 16, v90
  v_and_b32 v19, 0xffff0000, v90
  v_pk_fma_f32 v[44:45], v[18:19], v[54:55], v[44:45] op_sel:[0,0,0] op_sel_hi:[1,0,1]
  v_lshlrev_b32 v36, 16, v91
  v_and_b32 v37, 0xffff0000, v91
  v_pk_fma_f32 v[46:47], v[36:37], v[54:55], v[46:47] op_sel:[0,0,0] op_sel_hi:[1,0,1]
  v_lshlrev_b32 v18, 16, v92
  v_and_b32 v19, 0xffff0000, v92
  v_pk_fma_f32 v[40:41], v[18:19], v[54:55], v[40:41] op_sel:[0,1,0] op_sel_hi:[1,1,1]
  v_lshlrev_b32 v36, 16, v93
  v_and_b32 v37, 0xffff0000, v93
  v_pk_fma_f32 v[42:43], v[36:37], v[54:55], v[42:43] op_sel:[0,1,0] op_sel_hi:[1,1,1]
  v_lshlrev_b32 v18, 16, v94
  v_and_b32 v19, 0xffff0000, v94
  v_pk_fma_f32 v[44:45], v[18:19], v[54:55], v[44:45] op_sel:[0,1,0] op_sel_hi:[1,1,1]
  v_lshlrev_b32 v36, 16, v95
  v_and_b32 v37, 0xffff0000, v95
  v_pk_fma_f32 v[46:47], v[36:37], v[54:55], v[46:47] op_sel:[0,1,0] op_sel_hi:[1,1,1]
  s_waitcnt vmcnt(5)
  buffer_load_dwordx4 v[164:167], v3, s[52:55], s57 offen nt
  s_add_u32 s57, s57, 8192
  s_waitcnt lgkmcnt(0)
  ds_read_b128 v[52:55], v17 offset:27184
  v_lshlrev_b32 v18, 16, v96
  v_and_b32 v19, 0xffff0000, v96
  v_pk_fma_f32 v[40:41], v[18:19], v[48:49], v[40:41] op_sel:[0,0,0] op_sel_hi:[1,0,1]
  v_lshlrev_b32 v36, 16, v97
  v_and_b32 v37, 0xffff0000, v97
  v_pk_fma_f32 v[42:43], v[36:37], v[48:49], v[42:43] op_sel:[0,0,0] op_sel_hi:[1,0,1]
  v_lshlrev_b32 v18, 16, v98
  v_and_b32 v19, 0xffff0000, v98
  v_pk_fma_f32 v[44:45], v[18:19], v[48:49], v[44:45] op_sel:[0,0,0] op_sel_hi:[1,0,1]
  v_lshlrev_b32 v36, 16, v99
  v_and_b32 v37, 0xffff0000, v99
  v_pk_fma_f32 v[46:47], v[36:37], v[48:49], v[46:47] op_sel:[0,0,0] op_sel_hi:[1,0,1]
  v_lshlrev_b32 v18, 16, v100
  v_and_b32 v19, 0xffff0000, v100
  v_pk_fma_f32 v[40:41], v[18:19], v[48:49], v[40:41] op_sel:[0,1,0] op_sel_hi:[1,1,1]
  v_lshlrev_b32 v36, 16, v101
  v_and_b32 v37, 0xffff0000, v101
  v_pk_fma_f32 v[42:43], v[36:37], v[48:49], v[42:43] op_sel:[0,1,0] op_sel_hi:[1,1,1]
  v_lshlrev_b32 v18, 16, v102
  v_and_b32 v19, 0xffff0000, v102
  v_pk_fma_f32 v[44:45], v[18:19], v[48:49], v[44:45] op_sel:[0,1,0] op_sel_hi:[1,1,1]
  v_lshlrev_b32 v36, 16, v103
  v_and_b32 v37, 0xffff0000, v103
  v_pk_fma_f32 v[46:47], v[36:37], v[48:49], v[46:47] op_sel:[0,1,0] op_sel_hi:[1,1,1]
  v_lshlrev_b32 v18, 16, v104
  v_and_b32 v19, 0xffff0000, v104
  v_pk_fma_f32 v[40:41], v[18:19], v[50:51], v[40:41] op_sel:[0,0,0] op_sel_hi:[1,0,1]
  v_lshlrev_b32 v36, 16, v105
  v_and_b32 v37, 0xffff0000, v105
  v_pk_fma_f32 v[42:43], v[36:37], v[50:51], v[42:43] op_sel:[0,0,0] op_sel_hi:[1,0,1]
  v_lshlrev_b32 v18, 16, v106
  v_and_b32 v19, 0xffff0000, v106
  v_pk_fma_f32 v[44:45], v[18:19], v[50:51], v[44:45] op_sel:[0,0,0] op_sel_hi:[1,0,1]
  v_lshlrev_b32 v36, 16, v107
  v_and_b32 v37, 0xffff0000, v107
  v_pk_fma_f32 v[46:47], v[36:37], v[50:51], v[46:47] op_sel:[0,0,0] op_sel_hi:[1,0,1]
  v_lshlrev_b32 v18, 16, v108
  v_and_b32 v19, 0xffff0000, v108
  v_pk_fma_f32 v[40:41], v[18:19], v[50:51], v[40:41] op_sel:[0,1,0] op_sel_hi:[1,1,1]
  v_lshlrev_b32 v36, 16, v109
  v_and_b32 v37, 0xffff0000, v109
  v_pk_fma_f32 v[42:43], v[36:37], v[50:51], v[42:43] op_sel:[0,1,0] op_sel_hi:[1,1,1]
  v_lshlrev_b32 v18, 16, v110
  v_and_b32 v19, 0xffff0000, v110
  v_pk_fma_f32 v[44:45], v[18:19], v[50:51], v[44:45] op_sel:[0,1,0] op_sel_hi:[1,1,1]
  v_lshlrev_b32 v36, 16, v111
  v_and_b32 v37, 0xffff0000, v111
  v_pk_fma_f32 v[46:47], v[36:37], v[50:51], v[46:47] op_sel:[0,1,0] op_sel_hi:[1,1,1]
  s_waitcnt vmcnt(5)
  buffer_load_dwordx4 v[168:171], v3, s[52:55], s57 offen nt
  s_add_u32 s57, s57, 8192
  s_waitcnt lgkmcnt(0)
  ds_read_b128 v[48:51], v17 offset:27200
  v_lshlrev_b32 v18, 16, v112
  v_and_b32 v19, 0xffff0000, v112
  v_pk_fma_f32 v[40:41], v[18:19], v[52:53], v[40:41] op_sel:[0,0,0] op_sel_hi:[1,0,1]
  v_lshlrev_b32 v36, 16, v113
  v_and_b32 v37, 0xffff0000, v113
  v_pk_fma_f32 v[42:43], v[36:37], v[52:53], v[42:43] op_sel:[0,0,0] op_sel_hi:[1,0,1]
  v_lshlrev_b32 v18, 16, v114
  v_and_b32 v19, 0xffff0000, v114
  v_pk_fma_f32 v[44:45], v[18:19], v[52:53], v[44:45] op_sel:[0,0,0] op_sel_hi:[1,0,1]
  v_lshlrev_b32 v36, 16, v115
  v_and_b32 v37, 0xffff0000, v115
  v_pk_fma_f32 v[46:47], v[36:37], v[52:53], v[46:47] op_sel:[0,0,0] op_sel_hi:[1,0,1]
  v_lshlrev_b32 v18, 16, v116
  v_and_b32 v19, 0xffff0000, v116
  v_pk_fma_f32 v[40:41], v[18:19], v[52:53], v[40:41] op_sel:[0,1,0] op_sel_hi:[1,1,1]
  v_lshlrev_b32 v36, 16, v117
  v_and_b32 v37, 0xffff0000, v117
  v_pk_fma_f32 v[42:43], v[36:37], v[52:53], v[42:43] op_sel:[0,1,0] op_sel_hi:[1,1,1]
  v_lshlrev_b32 v18, 16, v118
  v_and_b32 v19, 0xffff0000, v118
  v_pk_fma_f32 v[44:45], v[18:19], v[52:53], v[44:45] op_sel:[0,1,0] op_sel_hi:[1,1,1]
  v_lshlrev_b32 v36, 16, v119
  v_and_b32 v37, 0xffff0000, v119
  v_pk_fma_f32 v[46:47], v[36:37], v[52:53], v[46:47] op_sel:[0,1,0] op_sel_hi:[1,1,1]
  v_lshlrev_b32 v18, 16, v120
  v_and_b32 v19, 0xffff0000, v120
  v_pk_fma_f32 v[40:41], v[18:19], v[54:55], v[40:41] op_sel:[0,0,0] op_sel_hi:[1,0,1]
  v_lshlrev_b32 v36, 16, v121
  v_and_b32 v37, 0xffff0000, v121
  v_pk_fma_f32 v[42:43], v[36:37], v[54:55], v[42:43] op_sel:[0,0,0] op_sel_hi:[1,0,1]
  v_lshlrev_b32 v18, 16, v122
  v_and_b32 v19, 0xffff0000, v122
  v_pk_fma_f32 v[44:45], v[18:19], v[54:55], v[44:45] op_sel:[0,0,0] op_sel_hi:[1,0,1]
  v_lshlrev_b32 v36, 16, v123
  v_and_b32 v37, 0xffff0000, v123
  v_pk_fma_f32 v[46:47], v[36:37], v[54:55], v[46:47] op_sel:[0,0,0] op_sel_hi:[1,0,1]
  v_lshlrev_b32 v18, 16, v124
  v_and_b32 v19, 0xffff0000, v124
  v_pk_fma_f32 v[40:41], v[18:19], v[54:55], v[40:41] op_sel:[0,1,0] op_sel_hi:[1,1,1]
  v_lshlrev_b32 v36, 16, v125
  v_and_b32 v37, 0xffff0000, v125
  v_pk_fma_f32 v[42:43], v[36:37], v[54:55], v[42:43] op_sel:[0,1,0] op_sel_hi:[1,1,1]
  v_lshlrev_b32 v18, 16, v126
  v_and_b32 v19, 0xffff0000, v126
  v_pk_fma_f32 v[44:45], v[18:19], v[54:55], v[44:45] op_sel:[0,1,0] op_sel_hi:[1,1,1]
  v_lshlrev_b32 v36, 16, v127
  v_and_b32 v37, 0xffff0000, v127
  v_pk_fma_f32 v[46:47], v[36:37], v[54:55], v[46:47] op_sel:[0,1,0] op_sel_hi:[1,1,1]
  s_waitcnt vmcnt(5)
  buffer_load_dwordx4 v[172:175], v3, s[52:55], s57 offen nt
  s_add_u32 s57, s57, 8192
  s_waitcnt lgkmcnt(0)
  ds_read_b128 v[52:55], v17 offset:27216
  v_lshlrev_b32 v18, 16, v128
  v_and_b32 v19, 0xffff0000, v128
  v_pk_fma_f32 v[40:41], v[18:19], v[48:49], v[40:41] op_sel:[0,0,0] op_sel_hi:[1,0,1]
  v_lshlrev_b32 v36, 16, v129
  v_and_b32 v37, 0xffff0000, v129
  v_pk_fma_f32 v[42:43], v[36:37], v[48:49], v[42:43] op_sel:[0,0,0] op_sel_hi:[1,0,1]
  v_lshlrev_b32 v18, 16, v130
  v_and_b32 v19, 0xffff0000, v130
  v_pk_fma_f32 v[44:45], v[18:19], v[48:49], v[44:45] op_sel:[0,0,0] op_sel_hi:[1,0,1]
  v_lshlrev_b32 v36, 16, v131
  v_and_b32 v37, 0xffff0000, v131
  v_pk_fma_f32 v[46:47], v[36:37], v[48:49], v[46:47] op_sel:[0,0,0] op_sel_hi:[1,0,1]
  v_lshlrev_b32 v18, 16, v132
  v_and_b32 v19, 0xffff0000, v132
  v_pk_fma_f32 v[40:41], v[18:19], v[48:49], v[40:41] op_sel:[0,1,0] op_sel_hi:[1,1,1]
  v_lshlrev_b32 v36, 16, v133
  v_and_b32 v37, 0xffff0000, v133
  v_pk_fma_f32 v[42:43], v[36:37], v[48:49], v[42:43] op_sel:[0,1,0] op_sel_hi:[1,1,1]
  v_lshlrev_b32 v18, 16, v134
  v_and_b32 v19, 0xffff0000, v134
  v_pk_fma_f32 v[44:45], v[18:19], v[48:49], v[44:45] op_sel:[0,1,0] op_sel_hi:[1,1,1]
  v_lshlrev_b32 v36, 16, v135
  v_and_b32 v37, 0xffff0000, v135
  v_pk_fma_f32 v[46:47], v[36:37], v[48:49], v[46:47] op_sel:[0,1,0] op_sel_hi:[1,1,1]
  v_lshlrev_b32 v18, 16, v136
  v_and_b32 v19, 0xffff0000, v136
  v_pk_fma_f32 v[40:41], v[18:19], v[50:51], v[40:41] op_sel:[0,0,0] op_sel_hi:[1,0,1]
  v_lshlrev_b32 v36, 16, v137
  v_and_b32 v37, 0xffff0000, v137
  v_pk_fma_f32 v[42:43], v[36:37], v[50:51], v[42:43] op_sel:[0,0,0] op_sel_hi:[1,0,1]
  v_lshlrev_b32 v18, 16, v138
  v_and_b32 v19, 0xffff0000, v138
  v_pk_fma_f32 v[44:45], v[18:19], v[50:51], v[44:45] op_sel:[0,0,0] op_sel_hi:[1,0,1]
  v_lshlrev_b32 v36, 16, v139
  v_and_b32 v37, 0xffff0000, v139
  v_pk_fma_f32 v[46:47], v[36:37], v[50:51], v[46:47] op_sel:[0,0,0] op_sel_hi:[1,0,1]
  v_lshlrev_b32 v18, 16, v140
  v_and_b32 v19, 0xffff0000, v140
  v_pk_fma_f32 v[40:41], v[18:19], v[50:51], v[40:41] op_sel:[0,1,0] op_sel_hi:[1,1,1]
  v_lshlrev_b32 v36, 16, v141
  v_and_b32 v37, 0xffff0000, v141
  v_pk_fma_f32 v[42:43], v[36:37], v[50:51], v[42:43] op_sel:[0,1,0] op_sel_hi:[1,1,1]
  v_lshlrev_b32 v18, 16, v142
  v_and_b32 v19, 0xffff0000, v142
  v_pk_fma_f32 v[44:45], v[18:19], v[50:51], v[44:45] op_sel:[0,1,0] op_sel_hi:[1,1,1]
  v_lshlrev_b32 v36, 16, v143
  v_and_b32 v37, 0xffff0000, v143
  v_pk_fma_f32 v[46:47], v[36:37], v[50:51], v[46:47] op_sel:[0,1,0] op_sel_hi:[1,1,1]
  s_waitcnt vmcnt(5)
  buffer_load_dwordx4 v[176:179], v3, s[52:55], s57 offen nt
  s_add_u32 s57, s57, 8192
  s_waitcnt lgkmcnt(0)
  ds_read_b128 v[48:51], v17 offset:27232
  v_lshlrev_b32 v18, 16, v144
  v_and_b32 v19, 0xffff0000, v144
  v_pk_fma_f32 v[40:41], v[18:19], v[52:53], v[40:41] op_sel:[0,0,0] op_sel_hi:[1,0,1]
  v_lshlrev_b32 v36, 16, v145
  v_and_b32 v37, 0xffff0000, v145
  v_pk_fma_f32 v[42:43], v[36:37], v[52:53], v[42:43] op_sel:[0,0,0] op_sel_hi:[1,0,1]
  v_lshlrev_b32 v18, 16, v146
  v_and_b32 v19, 0xffff0000, v146
  v_pk_fma_f32 v[44:45], v[18:19], v[52:53], v[44:45] op_sel:[0,0,0] op_sel_hi:[1,0,1]
  v_lshlrev_b32 v36, 16, v147
  v_and_b32 v37, 0xffff0000, v147
  v_pk_fma_f32 v[46:47], v[36:37], v[52:53], v[46:47] op_sel:[0,0,0] op_sel_hi:[1,0,1]
  v_lshlrev_b32 v18, 16, v148
  v_and_b32 v19, 0xffff0000, v148
  v_pk_fma_f32 v[40:41], v[18:19], v[52:53], v[40:41] op_sel:[0,1,0] op_sel_hi:[1,1,1]
  v_lshlrev_b32 v36, 16, v149
  v_and_b32 v37, 0xffff0000, v149
  v_pk_fma_f32 v[42:43], v[36:37], v[52:53], v[42:43] op_sel:[0,1,0] op_sel_hi:[1,1,1]
  v_lshlrev_b32 v18, 16, v150
  v_and_b32 v19, 0xffff0000, v150
  v_pk_fma_f32 v[44:45], v[18:19], v[52:53], v[44:45] op_sel:[0,1,0] op_sel_hi:[1,1,1]
  v_lshlrev_b32 v36, 16, v151
  v_and_b32 v37, 0xffff0000, v151
  v_pk_fma_f32 v[46:47], v[36:37], v[52:53], v[46:47] op_sel:[0,1,0] op_sel_hi:[1,1,1]
  v_lshlrev_b32 v18, 16, v152
  v_and_b32 v19, 0xffff0000, v152
  v_pk_fma_f32 v[40:41], v[18:19], v[54:55], v[40:41] op_sel:[0,0,0] op_sel_hi:[1,0,1]
  v_lshlrev_b32 v36, 16, v153
  v_and_b32 v37, 0xffff0000, v153
  v_pk_fma_f32 v[42:43], v[36:37], v[54:55], v[42:43] op_sel:[0,0,0] op_sel_hi:[1,0,1]
  v_lshlrev_b32 v18, 16, v154
  v_and_b32 v19, 0xffff0000, v154
  v_pk_fma_f32 v[44:45], v[18:19], v[54:55], v[44:45] op_sel:[0,0,0] op_sel_hi:[1,0,1]
  v_lshlrev_b32 v36, 16, v155
  v_and_b32 v37, 0xffff0000, v155
  v_pk_fma_f32 v[46:47], v[36:37], v[54:55], v[46:47] op_sel:[0,0,0] op_sel_hi:[1,0,1]
  s_waitcnt vmcnt(5)
  buffer_load_dwordx4 v[180:183], v3, s[52:55], s57 offen nt
  s_add_u32 s57, s57, 8192
  v_lshlrev_b32 v18, 16, v156
  v_and_b32 v19, 0xffff0000, v156
  v_pk_fma_f32 v[40:41], v[18:19], v[54:55], v[40:41] op_sel:[0,1,0] op_sel_hi:[1,1,1]
  v_lshlrev_b32 v36, 16, v157
  v_and_b32 v37, 0xffff0000, v157
  v_pk_fma_f32 v[42:43], v[36:37], v[54:55], v[42:43] op_sel:[0,1,0] op_sel_hi:[1,1,1]
  v_lshlrev_b32 v18, 16, v158
  v_and_b32 v19, 0xffff0000, v158
  v_pk_fma_f32 v[44:45], v[18:19], v[54:55], v[44:45] op_sel:[0,1,0] op_sel_hi:[1,1,1]
  v_lshlrev_b32 v36, 16, v159
  v_and_b32 v37, 0xffff0000, v159
  v_pk_fma_f32 v[46:47], v[36:37], v[54:55], v[46:47] op_sel:[0,1,0] op_sel_hi:[1,1,1]
  s_waitcnt vmcnt(5)
  buffer_load_dwordx4 v[184:187], v3, s[52:55], s57 offen nt
  s_add_u32 s57, s57, 8192
  s_waitcnt lgkmcnt(0)
  ds_read_b128 v[52:55], v17 offset:27248
  v_lshlrev_b32 v18, 16, v160
  v_and_b32 v19, 0xffff0000, v160
  v_pk_fma_f32 v[40:41], v[18:19], v[48:49], v[40:41] op_sel:[0,0,0] op_sel_hi:[1,0,1]
  v_lshlrev_b32 v36, 16, v161
  v_and_b32 v37, 0xffff0000, v161
  v_pk_fma_f32 v[42:43], v[36:37], v[48:49], v[42:43] op_sel:[0,0,0] op_sel_hi:[1,0,1]
  v_lshlrev_b32 v18, 16, v162
  v_and_b32 v19, 0xffff0000, v162
  v_pk_fma_f32 v[44:45], v[18:19], v[48:49], v[44:45] op_sel:[0,0,0] op_sel_hi:[1,0,1]
  v_lshlrev_b32 v36, 16, v163
  v_and_b32 v37, 0xffff0000, v163
  v_pk_fma_f32 v[46:47], v[36:37], v[48:49], v[46:47] op_sel:[0,0,0] op_sel_hi:[1,0,1]
  s_waitcnt vmcnt(5)
  buffer_load_dwordx4 v[188:191], v3, s[52:55], s57 offen nt
  s_add_u32 s57, s57, 8192
  v_lshlrev_b32 v18, 16, v164
  v_and_b32 v19, 0xffff0000, v164
  v_pk_fma_f32 v[40:41], v[18:19], v[48:49], v[40:41] op_sel:[0,1,0] op_sel_hi:[1,1,1]
  v_lshlrev_b32 v36, 16, v165
  v_and_b32 v37, 0xffff0000, v165
  v_pk_fma_f32 v[42:43], v[36:37], v[48:49], v[42:43] op_sel:[0,1,0] op_sel_hi:[1,1,1]
  v_lshlrev_b32 v18, 16, v166
  v_and_b32 v19, 0xffff0000, v166
  v_pk_fma_f32 v[44:45], v[18:19], v[48:49], v[44:45] op_sel:[0,1,0] op_sel_hi:[1,1,1]
  v_lshlrev_b32 v36, 16, v167
  v_and_b32 v37, 0xffff0000, v167
  v_pk_fma_f32 v[46:47], v[36:37], v[48:49], v[46:47] op_sel:[0,1,0] op_sel_hi:[1,1,1]
  s_waitcnt vmcnt(5)
  buffer_load_dwordx4 v[128:131], v3, s[52:55], s57 offen nt
  s_add_u32 s57, s57, 8192
  v_lshlrev_b32 v18, 16, v168
  v_and_b32 v19, 0xffff0000, v168
  v_pk_fma_f32 v[40:41], v[18:19], v[50:51], v[40:41] op_sel:[0,0,0] op_sel_hi:[1,0,1]
  v_lshlrev_b32 v36, 16, v169
  v_and_b32 v37, 0xffff0000, v169
  v_pk_fma_f32 v[42:43], v[36:37], v[50:51], v[42:43] op_sel:[0,0,0] op_sel_hi:[1,0,1]
  v_lshlrev_b32 v18, 16, v170
  v_and_b32 v19, 0xffff0000, v170
  v_pk_fma_f32 v[44:45], v[18:19], v[50:51], v[44:45] op_sel:[0,0,0] op_sel_hi:[1,0,1]
  v_lshlrev_b32 v36, 16, v171
  v_and_b32 v37, 0xffff0000, v171
  v_pk_fma_f32 v[46:47], v[36:37], v[50:51], v[46:47] op_sel:[0,0,0] op_sel_hi:[1,0,1]
  s_waitcnt vmcnt(5)
  buffer_load_dwordx4 v[132:135], v3, s[52:55], s57 offen nt
  s_add_u32 s57, s57, 8192
  v_lshlrev_b32 v18, 16, v172
  v_and_b32 v19, 0xffff0000, v172
  v_pk_fma_f32 v[40:41], v[18:19], v[50:51], v[40:41] op_sel:[0,1,0] op_sel_hi:[1,1,1]
  v_lshlrev_b32 v36, 16, v173
  v_and_b32 v37, 0xffff0000, v173
  v_pk_fma_f32 v[42:43], v[36:37], v[50:51], v[42:43] op_sel:[0,1,0] op_sel_hi:[1,1,1]
  v_lshlrev_b32 v18, 16, v174
  v_and_b32 v19, 0xffff0000, v174
  v_pk_fma_f32 v[44:45], v[18:19], v[50:51], v[44:45] op_sel:[0,1,0] op_sel_hi:[1,1,1]
  v_lshlrev_b32 v36, 16, v175
  v_and_b32 v37, 0xffff0000, v175
  v_pk_fma_f32 v[46:47], v[36:37], v[50:51], v[46:47] op_sel:[0,1,0] op_sel_hi:[1,1,1]
  s_waitcnt vmcnt(5)
  buffer_load_dwordx4 v[136:139], v3, s[52:55], s57 offen nt
  s_add_u32 s57, s57, 8192
  s_waitcnt lgkmcnt(0)
  ds_read_b128 v[48:51], v17 offset:27264
  v_lshlrev_b32 v18, 16, v176
  v_and_b32 v19, 0xffff0000, v176
  v_pk_fma_f32 v[40:41], v[18:19], v[52:53], v[40:41] op_sel:[0,0,0] op_sel_hi:[1,0,1]
  v_lshlrev_b32 v36, 16, v177
  v_and_b32 v37, 0xffff0000, v177
  v_pk_fma_f32 v[42:43], v[36:37], v[52:53], v[42:43] op_sel:[0,0,0] op_sel_hi:[1,0,1]
  v_lshlrev_b32 v18, 16, v178
  v_and_b32 v19, 0xffff0000, v178
  v_pk_fma_f32 v[44:45], v[18:19], v[52:53], v[44:45] op_sel:[0,0,0] op_sel_hi:[1,0,1]
  v_lshlrev_b32 v36, 16, v179
  v_and_b32 v37, 0xffff0000, v179
  v_pk_fma_f32 v[46:47], v[36:37], v[52:53], v[46:47] op_sel:[0,0,0] op_sel_hi:[1,0,1]
  s_waitcnt vmcnt(5)
  buffer_load_dwordx4 v[140:143], v3, s[52:55], s57 offen nt
  s_add_u32 s57, s57, 8192
  v_lshlrev_b32 v18, 16, v180
  v_and_b32 v19, 0xffff0000, v180
  v_pk_fma_f32 v[40:41], v[18:19], v[52:53], v[40:41] op_sel:[0,1,0] op_sel_hi:[1,1,1]
  v_lshlrev_b32 v36, 16, v181
  v_and_b32 v37, 0xffff0000, v181
  v_pk_fma_f32 v[42:43], v[36:37], v[52:53], v[42:43] op_sel:[0,1,0] op_sel_hi:[1,1,1]
  v_lshlrev_b32 v18, 16, v182
  v_and_b32 v19, 0xffff0000, v182
  v_pk_fma_f32 v[44:45], v[18:19], v[52:53], v[44:45] op_sel:[0,1,0] op_sel_hi:[1,1,1]
  v_lshlrev_b32 v36, 16, v183
  v_and_b32 v37, 0xffff0000, v183
  v_pk_fma_f32 v[46:47], v[36:37], v[52:53], v[46:47] op_sel:[0,1,0] op_sel_hi:[1,1,1]
  s_waitcnt vmcnt(5)
  buffer_load_dwordx4 v[144:147], v3, s[52:55], s57 offen nt
  s_add_u32 s57, s57, 8192
  v_lshlrev_b32 v18, 16, v184
  v_and_b32 v19, 0xffff0000, v184
  v_pk_fma_f32 v[40:41], v[18:19], v[54:55], v[40:41] op_sel:[0,0,0] op_sel_hi:[1,0,1]
  v_lshlrev_b32 v36, 16, v185
  v_and_b32 v37, 0xffff0000, v185
  v_pk_fma_f32 v[42:43], v[36:37], v[54:55], v[42:43] op_sel:[0,0,0] op_sel_hi:[1,0,1]
  v_lshlrev_b32 v18, 16, v186
  v_and_b32 v19, 0xffff0000, v186
  v_pk_fma_f32 v[44:45], v[18:19], v[54:55], v[44:45] op_sel:[0,0,0] op_sel_hi:[1,0,1]
  v_lshlrev_b32 v36, 16, v187
  v_and_b32 v37, 0xffff0000, v187
  v_pk_fma_f32 v[46:47], v[36:37], v[54:55], v[46:47] op_sel:[0,0,0] op_sel_hi:[1,0,1]
  s_waitcnt vmcnt(5)
  buffer_load_dwordx4 v[148:151], v3, s[52:55], s57 offen nt
  s_add_u32 s57, s57, 8192
  v_lshlrev_b32 v18, 16, v188
  v_and_b32 v19, 0xffff0000, v188
  v_pk_fma_f32 v[40:41], v[18:19], v[54:55], v[40:41] op_sel:[0,1,0] op_sel_hi:[1,1,1]
  v_lshlrev_b32 v36, 16, v189
  v_and_b32 v37, 0xffff0000, v189
  v_pk_fma_f32 v[42:43], v[36:37], v[54:55], v[42:43] op_sel:[0,1,0] op_sel_hi:[1,1,1]
  v_lshlrev_b32 v18, 16, v190
  v_and_b32 v19, 0xffff0000, v190
  v_pk_fma_f32 v[44:45], v[18:19], v[54:55], v[44:45] op_sel:[0,1,0] op_sel_hi:[1,1,1]
  v_lshlrev_b32 v36, 16, v191
  v_and_b32 v37, 0xffff0000, v191
  v_pk_fma_f32 v[46:47], v[36:37], v[54:55], v[46:47] op_sel:[0,1,0] op_sel_hi:[1,1,1]
  v_add_u32 v17, 256, v17
  s_mov_b32 s58, 11
L_VLOOP:
  s_waitcnt vmcnt(5)
  buffer_load_dwordx4 v[152:155], v3, s[52:55], s57 offen nt
  s_add_u32 s57, s57, 8192
  s_waitcnt lgkmcnt(0)
  ds_read_b128 v[52:55], v17 offset:27024
  v_lshlrev_b32 v18, 16, v128
  v_and_b32 v19, 0xffff0000, v128
  v_pk_fma_f32 v[40:41], v[18:19], v[48:49], v[40:41] op_sel:[0,0,0] op_sel_hi:[1,0,1]
  v_lshlrev_b32 v36, 16, v129
  v_and_b32 v37, 0xffff0000, v129
  v_pk_fma_f32 v[42:43], v[36:37], v[48:49], v[42:43] op_sel:[0,0,0] op_sel_hi:[1,0,1]
  v_lshlrev_b32 v18, 16, v130
  v_and_b32 v19, 0xffff0000, v130
  v_pk_fma_f32 v[44:45], v[18:19], v[48:49], v[44:45] op_sel:[0,0,0] op_sel_hi:[1,0,1]
  v_lshlrev_b32 v36, 16, v131
  v_and_b32 v37, 0xffff0000, v131
  v_pk_fma_f32 v[46:47], v[36:37], v[48:49], v[46:47] op_sel:[0,0,0] op_sel_hi:[1,0,1]
  s_waitcnt vmcnt(5)
  buffer_load_dwordx4 v[156:159], v3, s[52:55], s57 offen nt
  s_add_u32 s57, s57, 8192
  v_lshlrev_b32 v18, 16, v132
  v_and_b32 v19, 0xffff0000, v132
  v_pk_fma_f32 v[40:41], v[18:19], v[48:49], v[40:41] op_sel:[0,1,0] op_sel_hi:[1,1,1]
  v_lshlrev_b32 v36, 16, v133
  v_and_b32 v37, 0xffff0000, v133
  v_pk_fma_f32 v[42:43], v[36:37], v[48:49], v[42:43] op_sel:[0,1,0] op_sel_hi:[1,1,1]
  v_lshlrev_b32 v18, 16, v134
  v_and_b32 v19, 0xffff0000, v134
  v_pk_fma_f32 v[44:45], v[18:19], v[48:49], v[44:45] op_sel:[0,1,0] op_sel_hi:[1,1,1]
  v_lshlrev_b32 v36, 16, v135
  v_and_b32 v37, 0xffff0000, v135
  v_pk_fma_f32 v[46:47], v[36:37], v[48:49], v[46:47] op_sel:[0,1,0] op_sel_hi:[1,1,1]
  s_waitcnt vmcnt(5)
  buffer_load_dwordx4 v[160:163], v3, s[52:55], s57 offen nt
  s_add_u32 s57, s57, 8192
  v_lshlrev_b32 v18, 16, v136
  v_and_b32 v19, 0xffff0000, v136
  v_pk_fma_f32 v[40:41], v[18:19], v[50:51], v[40:41] op_sel:[0,0,0] op_sel_hi:[1,0,1]
  v_lshlrev_b32 v36, 16, v137
  v_and_b32 v37, 0xffff0000, v137
  v_pk_fma_f32 v[42:43], v[36:37], v[50:51], v[42:43] op_sel:[0,0,0] op_sel_hi:[1,0,1]
  v_lshlrev_b32 v18, 16, v138
  v_and_b32 v19, 0xffff0000, v138
  v_pk_fma_f32 v[44:45], v[18:19], v[50:51], v[44:45] op_sel:[0,0,0] op_sel_hi:[1,0,1]
  v_lshlrev_b32 v36, 16, v139
  v_and_b32 v37, 0xffff0000, v139
  v_pk_fma_f32 v[46:47], v[36:37], v[50:51], v[46:47] op_sel:[0,0,0] op_sel_hi:[1,0,1]
  s_waitcnt vmcnt(5)
  buffer_load_dwordx4 v[164:167], v3, s[52:55], s57 offen nt
  s_add_u32 s57, s57, 8192
  v_lshlrev_b32 v18, 16, v140
  v_and_b32 v19, 0xffff0000, v140
  v_pk_fma_f32 v[40:41], v[18:19], v[50:51], v[40:41] op_sel:[0,1,0] op_sel_hi:[1,1,1]
  v_lshlrev_b32 v36, 16, v141
  v_and_b32 v37, 0xffff0000, v141
  v_pk_fma_f32 v[42:43], v[36:37], v[50:51], v[42:43] op_sel:[0,1,0] op_sel_hi:[1,1,1]
  v_lshlrev_b32 v18, 16, v142
  v_and_b32 v19, 0xffff0000, v142
  v_pk_fma_f32 v[44:45], v[18:19], v[50:51], v[44:45] op_sel:[0,1,0] op_sel_hi:[1,1,1]
  v_lshlrev_b32 v36, 16, v143
  v_and_b32 v37, 0xffff0000, v143
  v_pk_fma_f32 v[46:47], v[36:37], v[50:51], v[46:47] op_sel:[0,1,0] op_sel_hi:[1,1,1]
  s_waitcnt vmcnt(5)
  buffer_load_dwordx4 v[168:171], v3, s[52:55], s57 offen nt
  s_add_u32 s57, s57, 8192
  s_waitcnt lgkmcnt(0)
  ds_read_b128 v[48:51], v17 offset:27040
  v_lshlrev_b32 v18, 16, v144
  v_and_b32 v19, 0xffff0000, v144
  v_pk_fma_f32 v[40:41], v[18:19], v[52:53], v[40:41] op_sel:[0,0,0] op_sel_hi:[1,0,1]
  v_lshlrev_b32 v36, 16, v145
  v_and_b32 v37, 0xffff0000, v145
  v_pk_fma_f32 v[42:43], v[36:37], v[52:53], v[42:43] op_sel:[0,0,0] op_sel_hi:[1,0,1]
  v_lshlrev_b32 v18, 16, v146
  v_and_b32 v19, 0xffff0000, v146
  v_pk_fma_f32 v[44:45], v[18:19], v[52:53], v[44:45] op_sel:[0,0,0] op_sel_hi:[1,0,1]
  v_lshlrev_b32 v36, 16, v147
  v_and_b32 v37, 0xffff0000, v147
  v_pk_fma_f32 v[46:47], v[36:37], v[52:53], v[46:47] op_sel:[0,0,0] op_sel_hi:[1,0,1]
  s_waitcnt vmcnt(5)
  buffer_load_dwordx4 v[172:175], v3, s[52:55], s57 offen nt
  s_add_u32 s57, s57, 8192
  v_lshlrev_b32 v18, 16, v148
  v_and_b32 v19, 0xffff0000, v148
  v_pk_fma_f32 v[40:41], v[18:19], v[52:53], v[40:41] op_sel:[0,1,0] op_sel_hi:[1,1,1]
  v_lshlrev_b32 v36, 16, v149
  v_and_b32 v37, 0xffff0000, v149
  v_pk_fma_f32 v[42:43], v[36:37], v[52:53], v[42:43] op_sel:[0,1,0] op_sel_hi:[1,1,1]
  v_lshlrev_b32 v18, 16, v150
  v_and_b32 v19, 0xffff0000, v150
  v_pk_fma_f32 v[44:45], v[18:19], v[52:53], v[44:45] op_sel:[0,1,0] op_sel_hi:[1,1,1]
  v_lshlrev_b32 v36, 16, v151
  v_and_b32 v37, 0xffff0000, v151
  v_pk_fma_f32 v[46:47], v[36:37], v[52:53], v[46:47] op_sel:[0,1,0] op_sel_hi:[1,1,1]
  s_waitcnt vmcnt(5)
  buffer_load_dwordx4 v[176:179], v3, s[52:55], s57 offen nt
  s_add_u32 s57, s57, 8192
  v_lshlrev_b32 v18, 16, v152
  v_and_b32 v19, 0xffff0000, v152
  v_pk_fma_f32 v[40:41], v[18:19], v[54:55], v[40:41] op_sel:[0,0,0] op_sel_hi:[1,0,1]
  v_lshlrev_b32 v36, 16, v153
  v_and_b32 v37, 0xffff0000, v153
  v_pk_fma_f32 v[42:43], v[36:37], v[54:55], v[42:43] op_sel:[0,0,0] op_sel_hi:[1,0,1]
  v_lshlrev_b32 v18, 16, v154
  v_and_b32 v19, 0xffff0000, v154
  v_pk_fma_f32 v[44:45], v[18:19], v[54:55], v[44:45] op_sel:[0,0,0] op_sel_hi:[1,0,1]
  v_lshlrev_b32 v36, 16, v155
  v_and_b32 v37, 0xffff0000, v155
  v_pk_fma_f32 v[46:47], v[36:37], v[54:55], v[46:47] op_sel:[0,0,0] op_sel_hi:[1,0,1]
  s_waitcnt vmcnt(5)
  buffer_load_dwordx4 v[180:183], v3, s[52:55], s57 offen nt
  s_add_u32 s57, s57, 8192
  v_lshlrev_b32 v18, 16, v156
  v_and_b32 v19, 0xffff0000, v156
  v_pk_fma_f32 v[40:41], v[18:19], v[54:55], v[40:41] op_sel:[0,1,0] op_sel_hi:[1,1,1]
  v_lshlrev_b32 v36, 16, v157
  v_and_b32 v37, 0xffff0000, v157
  v_pk_fma_f32 v[42:43], v[36:37], v[54:55], v[42:43] op_sel:[0,1,0] op_sel_hi:[1,1,1]
  v_lshlrev_b32 v18, 16, v158
  v_and_b32 v19, 0xffff0000, v158
  v_pk_fma_f32 v[44:45], v[18:19], v[54:55], v[44:45] op_sel:[0,1,0] op_sel_hi:[1,1,1]
  v_lshlrev_b32 v36, 16, v159
  v_and_b32 v37, 0xffff0000, v159
  v_pk_fma_f32 v[46:47], v[36:37], v[54:55], v[46:47] op_sel:[0,1,0] op_sel_hi:[1,1,1]
  s_waitcnt vmcnt(5)
  buffer_load_dwordx4 v[184:187], v3, s[52:55], s57 offen nt
  s_add_u32 s57, s57, 8192
  s_waitcnt lgkmcnt(0)
  ds_read_b128 v[52:55], v17 offset:27056
  v_lshlrev_b32 v18, 16, v160
  v_and_b32 v19, 0xffff0000, v160
  v_pk_fma_f32 v[40:41], v[18:19], v[48:49], v[40:41] op_sel:[0,0,0] op_sel_hi:[1,0,1]
  v_lshlrev_b32 v36, 16, v161
  v_and_b32 v37, 0xffff0000, v161
  v_pk_fma_f32 v[42:43], v[36:37], v[48:49], v[42:43] op_sel:[0,0,0] op_sel_hi:[1,0,1]
  v_lshlrev_b32 v18, 16, v162
  v_and_b32 v19, 0xffff0000, v162
  v_pk_fma_f32 v[44:45], v[18:19], v[48:49], v[44:45] op_sel:[0,0,0] op_sel_hi:[1,0,1]
  v_lshlrev_b32 v36, 16, v163
  v_and_b32 v37, 0xffff0000, v163
  v_pk_fma_f32 v[46:47], v[36:37], v[48:49], v[46:47] op_sel:[0,0,0] op_sel_hi:[1,0,1]
  s_waitcnt vmcnt(5)
  buffer_load_dwordx4 v[188:191], v3, s[52:55], s57 offen nt
  s_add_u32 s57, s57, 8192
  v_lshlrev_b32 v18, 16, v164
  v_and_b32 v19, 0xffff0000, v164
  v_pk_fma_f32 v[40:41], v[18:19], v[48:49], v[40:41] op_sel:[0,1,0] op_sel_hi:[1,1,1]
  v_lshlrev_b32 v36, 16, v165
  v_and_b32 v37, 0xffff0000, v165
  v_pk_fma_f32 v[42:43], v[36:37], v[48:49], v[42:43] op_sel:[0,1,0] op_sel_hi:[1,1,1]
  v_lshlrev_b32 v18, 16, v166
  v_and_b32 v19, 0xffff0000, v166
  v_pk_fma_f32 v[44:45], v[18:19], v[48:49], v[44:45] op_sel:[0,1,0] op_sel_hi:[1,1,1]
  v_lshlrev_b32 v36, 16, v167
  v_and_b32 v37, 0xffff0000, v167
  v_pk_fma_f32 v[46:47], v[36:37], v[48:49], v[46:47] op_sel:[0,1,0] op_sel_hi:[1,1,1]
  s_waitcnt vmcnt(5)
  buffer_load_dwordx4 v[128:131], v3, s[52:55], s57 offen nt
  s_add_u32 s57, s57, 8192
  v_lshlrev_b32 v18, 16, v168
  v_and_b32 v19, 0xffff0000, v168
  v_pk_fma_f32 v[40:41], v[18:19], v[50:51], v[40:41] op_sel:[0,0,0] op_sel_hi:[1,0,1]
  v_lshlrev_b32 v36, 16, v169
  v_and_b32 v37, 0xffff0000, v169
  v_pk_fma_f32 v[42:43], v[36:37], v[50:51], v[42:43] op_sel:[0,0,0] op_sel_hi:[1,0,1]
  v_lshlrev_b32 v18, 16, v170
  v_and_b32 v19, 0xffff0000, v170
  v_pk_fma_f32 v[44:45], v[18:19], v[50:51], v[44:45] op_sel:[0,0,0] op_sel_hi:[1,0,1]
  v_lshlrev_b32 v36, 16, v171
  v_and_b32 v37, 0xffff0000, v171
  v_pk_fma_f32 v[46:47], v[36:37], v[50:51], v[46:47] op_sel:[0,0,0] op_sel_hi:[1,0,1]
  s_waitcnt vmcnt(5)
  buffer_load_dwordx4 v[132:135], v3, s[52:55], s57 offen nt
  s_add_u32 s57, s57, 8192
  v_lshlrev_b32 v18, 16, v172
  v_and_b32 v19, 0xffff0000, v172
  v_pk_fma_f32 v[40:41], v[18:19], v[50:51], v[40:41] op_sel:[0,1,0] op_sel_hi:[1,1,1]
  v_lshlrev_b32 v36, 16, v173
  v_and_b32 v37, 0xffff0000, v173
  v_pk_fma_f32 v[42:43], v[36:37], v[50:51], v[42:43] op_sel:[0,1,0] op_sel_hi:[1,1,1]
  v_lshlrev_b32 v18, 16, v174
  v_and_b32 v19, 0xffff0000, v174
  v_pk_fma_f32 v[44:45], v[18:19], v[50:51], v[44:45] op_sel:[0,1,0] op_sel_hi:[1,1,1]
  v_lshlrev_b32 v36, 16, v175
  v_and_b32 v37, 0xffff0000, v175
  v_pk_fma_f32 v[46:47], v[36:37], v[50:51], v[46:47] op_sel:[0,1,0] op_sel_hi:[1,1,1]
  s_waitcnt vmcnt(5)
  buffer_load_dwordx4 v[136:139], v3, s[52:55], s57 offen nt
  s_add_u32 s57, s57, 8192
  s_waitcnt lgkmcnt(0)
  ds_read_b128 v[48:51], v17 offset:27072
  v_lshlrev_b32 v18, 16, v176
  v_and_b32 v19, 0xffff0000, v176
  v_pk_fma_f32 v[40:41], v[18:19], v[52:53], v[40:41] op_sel:[0,0,0] op_sel_hi:[1,0,1]
  v_lshlrev_b32 v36, 16, v177
  v_and_b32 v37, 0xffff0000, v177
  v_pk_fma_f32 v[42:43], v[36:37], v[52:53], v[42:43] op_sel:[0,0,0] op_sel_hi:[1,0,1]
  v_lshlrev_b32 v18, 16, v178
  v_and_b32 v19, 0xffff0000, v178
  v_pk_fma_f32 v[44:45], v[18:19], v[52:53], v[44:45] op_sel:[0,0,0] op_sel_hi:[1,0,1]
  v_lshlrev_b32 v36, 16, v179
  v_and_b32 v37, 0xffff0000, v179
  v_pk_fma_f32 v[46:47], v[36:37], v[52:53], v[46:47] op_sel:[0,0,0] op_sel_hi:[1,0,1]
  s_waitcnt vmcnt(5)
  buffer_load_dwordx4 v[140:143], v3, s[52:55], s57 offen nt
  s_add_u32 s57, s57, 8192
  v_lshlrev_b32 v18, 16, v180
  v_and_b32 v19, 0xffff0000, v180
  v_pk_fma_f32 v[40:41], v[18:19], v[52:53], v[40:41] op_sel:[0,1,0] op_sel_hi:[1,1,1]
  v_lshlrev_b32 v36, 16, v181
  v_and_b32 v37, 0xffff0000, v181
  v_pk_fma_f32 v[42:43], v[36:37], v[52:53], v[42:43] op_sel:[0,1,0] op_sel_hi:[1,1,1]
  v_lshlrev_b32 v18, 16, v182
  v_and_b32 v19, 0xffff0000, v182
  v_pk_fma_f32 v[44:45], v[18:19], v[52:53], v[44:45] op_sel:[0,1,0] op_sel_hi:[1,1,1]
  v_lshlrev_b32 v36, 16, v183
  v_and_b32 v37, 0xffff0000, v183
  v_pk_fma_f32 v[46:47], v[36:37], v[52:53], v[46:47] op_sel:[0,1,0] op_sel_hi:[1,1,1]
  s_waitcnt vmcnt(5)
  buffer_load_dwordx4 v[144:147], v3, s[52:55], s57 offen nt
  s_add_u32 s57, s57, 8192
  v_lshlrev_b32 v18, 16, v184
  v_and_b32 v19, 0xffff0000, v184
  v_pk_fma_f32 v[40:41], v[18:19], v[54:55], v[40:41] op_sel:[0,0,0] op_sel_hi:[1,0,1]
  v_lshlrev_b32 v36, 16, v185
  v_and_b32 v37, 0xffff0000, v185
  v_pk_fma_f32 v[42:43], v[36:37], v[54:55], v[42:43] op_sel:[0,0,0] op_sel_hi:[1,0,1]
  v_lshlrev_b32 v18, 16, v186
  v_and_b32 v19, 0xffff0000, v186
  v_pk_fma_f32 v[44:45], v[18:19], v[54:55], v[44:45] op_sel:[0,0,0] op_sel_hi:[1,0,1]
  v_lshlrev_b32 v36, 16, v187
  v_and_b32 v37, 0xffff0000, v187
  v_pk_fma_f32 v[46:47], v[36:37], v[54:55], v[46:47] op_sel:[0,0,0] op_sel_hi:[1,0,1]
  s_waitcnt vmcnt(5)
  buffer_load_dwordx4 v[148:151], v3, s[52:55], s57 offen nt
  s_add_u32 s57, s57, 8192
  v_lshlrev_b32 v18, 16, v188
  v_and_b32 v19, 0xffff0000, v188
  v_pk_fma_f32 v[40:41], v[18:19], v[54:55], v[40:41] op_sel:[0,1,0] op_sel_hi:[1,1,1]
  v_lshlrev_b32 v36, 16, v189
  v_and_b32 v37, 0xffff0000, v189
  v_pk_fma_f32 v[42:43], v[36:37], v[54:55], v[42:43] op_sel:[0,1,0] op_sel_hi:[1,1,1]
  v_lshlrev_b32 v18, 16, v190
  v_and_b32 v19, 0xffff0000, v190
  v_pk_fma_f32 v[44:45], v[18:19], v[54:55], v[44:45] op_sel:[0,1,0] op_sel_hi:[1,1,1]
  v_lshlrev_b32 v36, 16, v191
  v_and_b32 v37, 0xffff0000, v191
  v_pk_fma_f32 v[46:47], v[36:37], v[54:55], v[46:47] op_sel:[0,1,0] op_sel_hi:[1,1,1]
  v_add_u32 v17, 64, v17
  s_sub_u32 s58, s58, 1
  s_cmp_lg_u32 s58, 0
  s_cbranch_scc1 L_VLOOP
  s_waitcnt vmcnt(5)
  buffer_load_dwordx4 v[152:155], v3, s[52:55], s57 offen nt
  s_add_u32 s57, s57, 8192
  s_waitcnt lgkmcnt(0)
  ds_read_b128 v[52:55], v17 offset:27024
  v_lshlrev_b32 v18, 16, v128
  v_and_b32 v19, 0xffff0000, v128
  v_pk_fma_f32 v[40:41], v[18:19], v[48:49], v[40:41] op_sel:[0,0,0] op_sel_hi:[1,0,1]
  v_lshlrev_b32 v36, 16, v129
  v_and_b32 v37, 0xffff0000, v129
  v_pk_fma_f32 v[42:43], v[36:37], v[48:49], v[42:43] op_sel:[0,0,0] op_sel_hi:[1,0,1]
  v_lshlrev_b32 v18, 16, v130
  v_and_b32 v19, 0xffff0000, v130
  v_pk_fma_f32 v[44:45], v[18:19], v[48:49], v[44:45] op_sel:[0,0,0] op_sel_hi:[1,0,1]
  v_lshlrev_b32 v36, 16, v131
  v_and_b32 v37, 0xffff0000, v131
  v_pk_fma_f32 v[46:47], v[36:37], v[48:49], v[46:47] op_sel:[0,0,0] op_sel_hi:[1,0,1]
  s_waitcnt vmcnt(5)
  buffer_load_dwordx4 v[156:159], v3, s[52:55], s57 offen nt
  s_add_u32 s57, s57, 8192
  v_lshlrev_b32 v18, 16, v132
  v_and_b32 v19, 0xffff0000, v132
  v_pk_fma_f32 v[40:41], v[18:19], v[48:49], v[40:41] op_sel:[0,1,0] op_sel_hi:[1,1,1]
  v_lshlrev_b32 v36, 16, v133
  v_and_b32 v37, 0xffff0000, v133
  v_pk_fma_f32 v[42:43], v[36:37], v[48:49], v[42:43] op_sel:[0,1,0] op_sel_hi:[1,1,1]
  v_lshlrev_b32 v18, 16, v134
  v_and_b32 v19, 0xffff0000, v134
  v_pk_fma_f32 v[44:45], v[18:19], v[48:49], v[44:45] op_sel:[0,1,0] op_sel_hi:[1,1,1]
  v_lshlrev_b32 v36, 16, v135
  v_and_b32 v37, 0xffff0000, v135
  v_pk_fma_f32 v[46:47], v[36:37], v[48:49], v[46:47] op_sel:[0,1,0] op_sel_hi:[1,1,1]
  s_waitcnt vmcnt(5)
  buffer_load_dwordx4 v[160:163], v3, s[52:55], s57 offen nt
  s_add_u32 s57, s57, 8192
  v_lshlrev_b32 v18, 16, v136
  v_and_b32 v19, 0xffff0000, v136
  v_pk_fma_f32 v[40:41], v[18:19], v[50:51], v[40:41] op_sel:[0,0,0] op_sel_hi:[1,0,1]
  v_lshlrev_b32 v36, 16, v137
  v_and_b32 v37, 0xffff0000, v137
  v_pk_fma_f32 v[42:43], v[36:37], v[50:51], v[42:43] op_sel:[0,0,0] op_sel_hi:[1,0,1]
  v_lshlrev_b32 v18, 16, v138
  v_and_b32 v19, 0xffff0000, v138
  v_pk_fma_f32 v[44:45], v[18:19], v[50:51], v[44:45] op_sel:[0,0,0] op_sel_hi:[1,0,1]
  v_lshlrev_b32 v36, 16, v139
  v_and_b32 v37, 0xffff0000, v139
  v_pk_fma_f32 v[46:47], v[36:37], v[50:51], v[46:47] op_sel:[0,0,0] op_sel_hi:[1,0,1]
  s_waitcnt vmcnt(5)
  buffer_load_dwordx4 v[164:167], v3, s[52:55], s57 offen nt
  s_add_u32 s57, s57, 8192
  v_lshlrev_b32 v18, 16, v140
  v_and_b32 v19, 0xffff0000, v140
  v_pk_fma_f32 v[40:41], v[18:19], v[50:51], v[40:41] op_sel:[0,1,0] op_sel_hi:[1,1,1]
  v_lshlrev_b32 v36, 16, v141
  v_and_b32 v37, 0xffff0000, v141
  v_pk_fma_f32 v[42:43], v[36:37], v[50:51], v[42:43] op_sel:[0,1,0] op_sel_hi:[1,1,1]
  v_lshlrev_b32 v18, 16, v142
  v_and_b32 v19, 0xffff0000, v142
  v_pk_fma_f32 v[44:45], v[18:19], v[50:51], v[44:45] op_sel:[0,1,0] op_sel_hi:[1,1,1]
  v_lshlrev_b32 v36, 16, v143
  v_and_b32 v37, 0xffff0000, v143
  v_pk_fma_f32 v[46:47], v[36:37], v[50:51], v[46:47] op_sel:[0,1,0] op_sel_hi:[1,1,1]
  s_waitcnt vmcnt(5)
  buffer_load_dwordx4 v[168:171], v3, s[52:55], s57 offen nt
  s_add_u32 s57, s57, 8192
  s_waitcnt lgkmcnt(0)
  ds_read_b128 v[48:51], v17 offset:27040
  v_lshlrev_b32 v18, 16, v144
  v_and_b32 v19, 0xffff0000, v144
  v_pk_fma_f32 v[40:41], v[18:19], v[52:53], v[40:41] op_sel:[0,0,0] op_sel_hi:[1,0,1]
  v_lshlrev_b32 v36, 16, v145
  v_and_b32 v37, 0xffff0000, v145
  v_pk_fma_f32 v[42:43], v[36:37], v[52:53], v[42:43] op_sel:[0,0,0] op_sel_hi:[1,0,1]
  v_lshlrev_b32 v18, 16, v146
  v_and_b32 v19, 0xffff0000, v146
  v_pk_fma_f32 v[44:45], v[18:19], v[52:53], v[44:45] op_sel:[0,0,0] op_sel_hi:[1,0,1]
  v_lshlrev_b32 v36, 16, v147
  v_and_b32 v37, 0xffff0000, v147
  v_pk_fma_f32 v[46:47], v[36:37], v[52:53], v[46:47] op_sel:[0,0,0] op_sel_hi:[1,0,1]
  s_waitcnt vmcnt(5)
  buffer_load_dwordx4 v[172:175], v3, s[52:55], s57 offen nt
  s_add_u32 s57, s57, 8192
  v_lshlrev_b32 v18, 16, v148
  v_and_b32 v19, 0xffff0000, v148
  v_pk_fma_f32 v[40:41], v[18:19], v[52:53], v[40:41] op_sel:[0,1,0] op_sel_hi:[1,1,1]
  v_lshlrev_b32 v36, 16, v149
  v_and_b32 v37, 0xffff0000, v149
  v_pk_fma_f32 v[42:43], v[36:37], v[52:53], v[42:43] op_sel:[0,1,0] op_sel_hi:[1,1,1]
  v_lshlrev_b32 v18, 16, v150
  v_and_b32 v19, 0xffff0000, v150
  v_pk_fma_f32 v[44:45], v[18:19], v[52:53], v[44:45] op_sel:[0,1,0] op_sel_hi:[1,1,1]
  v_lshlrev_b32 v36, 16, v151
  v_and_b32 v37, 0xffff0000, v151
  v_pk_fma_f32 v[46:47], v[36:37], v[52:53], v[46:47] op_sel:[0,1,0] op_sel_hi:[1,1,1]
  s_waitcnt vmcnt(5)
  buffer_load_dwordx4 v[176:179], v3, s[52:55], s57 offen nt
  s_add_u32 s57, s57, 8192
  ds_add_u32 v6, v7 offset:40
  v_lshlrev_b32 v18, 16, v152
  v_and_b32 v19, 0xffff0000, v152
  v_pk_fma_f32 v[40:41], v[18:19], v[54:55], v[40:41] op_sel:[0,0,0] op_sel_hi:[1,0,1]
  v_lshlrev_b32 v36, 16, v153
  v_and_b32 v37, 0xffff0000, v153
  v_pk_fma_f32 v[42:43], v[36:37], v[54:55], v[42:43] op_sel:[0,0,0] op_sel_hi:[1,0,1]
  v_lshlrev_b32 v18, 16, v154
  v_and_b32 v19, 0xffff0000, v154
  v_pk_fma_f32 v[44:45], v[18:19], v[54:55], v[44:45] op_sel:[0,0,0] op_sel_hi:[1,0,1]
  v_lshlrev_b32 v36, 16, v155
  v_and_b32 v37, 0xffff0000, v155
  v_pk_fma_f32 v[46:47], v[36:37], v[54:55], v[46:47] op_sel:[0,0,0] op_sel_hi:[1,0,1]
  s_waitcnt vmcnt(5)
  buffer_load_dwordx4 v[180:183], v3, s[52:55], s57 offen nt
  s_add_u32 s57, s57, 8192
  v_lshlrev_b32 v18, 16, v156
  v_and_b32 v19, 0xffff0000, v156
  v_pk_fma_f32 v[40:41], v[18:19], v[54:55], v[40:41] op_sel:[0,1,0] op_sel_hi:[1,1,1]
  v_lshlrev_b32 v36, 16, v157
  v_and_b32 v37, 0xffff0000, v157
  v_pk_fma_f32 v[42:43], v[36:37], v[54:55], v[42:43] op_sel:[0,1,0] op_sel_hi:[1,1,1]
  v_lshlrev_b32 v18, 16, v158
  v_and_b32 v19, 0xffff0000, v158
  v_pk_fma_f32 v[44:45], v[18:19], v[54:55], v[44:45] op_sel:[0,1,0] op_sel_hi:[1,1,1]
  v_lshlrev_b32 v36, 16, v159
  v_and_b32 v37, 0xffff0000, v159
  v_pk_fma_f32 v[46:47], v[36:37], v[54:55], v[46:47] op_sel:[0,1,0] op_sel_hi:[1,1,1]
  s_waitcnt vmcnt(5)
  buffer_load_dwordx4 v[184:187], v3, s[52:55], s57 offen nt
  s_add_u32 s57, s57, 8192
  s_waitcnt lgkmcnt(0)
  ds_read_b128 v[52:55], v17 offset:27056
  v_lshlrev_b32 v18, 16, v160
  v_and_b32 v19, 0xffff0000, v160
  v_pk_fma_f32 v[40:41], v[18:19], v[48:49], v[40:41] op_sel:[0,0,0] op_sel_hi:[1,0,1]
  v_lshlrev_b32 v36, 16, v161
  v_and_b32 v37, 0xffff0000, v161
  v_pk_fma_f32 v[42:43], v[36:37], v[48:49], v[42:43] op_sel:[0,0,0] op_sel_hi:[1,0,1]
  v_lshlrev_b32 v18, 16, v162
  v_and_b32 v19, 0xffff0000, v162
  v_pk_fma_f32 v[44:45], v[18:19], v[48:49], v[44:45] op_sel:[0,0,0] op_sel_hi:[1,0,1]
  v_lshlrev_b32 v36, 16, v163
  v_and_b32 v37, 0xffff0000, v163
  v_pk_fma_f32 v[46:47], v[36:37], v[48:49], v[46:47] op_sel:[0,0,0] op_sel_hi:[1,0,1]
  s_waitcnt vmcnt(5)
  buffer_load_dwordx4 v[188:191], v3, s[52:55], s57 offen nt
  s_add_u32 s57, s57, 8192
  v_lshlrev_b32 v18, 16, v164
  v_and_b32 v19, 0xffff0000, v164
  v_pk_fma_f32 v[40:41], v[18:19], v[48:49], v[40:41] op_sel:[0,1,0] op_sel_hi:[1,1,1]
  v_lshlrev_b32 v36, 16, v165
  v_and_b32 v37, 0xffff0000, v165
  v_pk_fma_f32 v[42:43], v[36:37], v[48:49], v[42:43] op_sel:[0,1,0] op_sel_hi:[1,1,1]
  v_lshlrev_b32 v18, 16, v166
  v_and_b32 v19, 0xffff0000, v166
  v_pk_fma_f32 v[44:45], v[18:19], v[48:49], v[44:45] op_sel:[0,1,0] op_sel_hi:[1,1,1]
  v_lshlrev_b32 v36, 16, v167
  v_and_b32 v37, 0xffff0000, v167
  v_pk_fma_f32 v[46:47], v[36:37], v[48:49], v[46:47] op_sel:[0,1,0] op_sel_hi:[1,1,1]
  s_waitcnt vmcnt(5)
  v_lshlrev_b32 v18, 16, v168
  v_and_b32 v19, 0xffff0000, v168
  v_pk_fma_f32 v[40:41], v[18:19], v[50:51], v[40:41] op_sel:[0,0,0] op_sel_hi:[1,0,1]
  v_lshlrev_b32 v36, 16, v169
  v_and_b32 v37, 0xffff0000, v169
  v_pk_fma_f32 v[42:43], v[36:37], v[50:51], v[42:43] op_sel:[0,0,0] op_sel_hi:[1,0,1]
  v_lshlrev_b32 v18, 16, v170
  v_and_b32 v19, 0xffff0000, v170
  v_pk_fma_f32 v[44:45], v[18:19], v[50:51], v[44:45] op_sel:[0,0,0] op_sel_hi:[1,0,1]
  v_lshlrev_b32 v36, 16, v171
  v_and_b32 v37, 0xffff0000, v171
  v_pk_fma_f32 v[46:47], v[36:37], v[50:51], v[46:47] op_sel:[0,0,0] op_sel_hi:[1,0,1]
  s_waitcnt vmcnt(4)
  v_lshlrev_b32 v18, 16, v172
  v_and_b32 v19, 0xffff0000, v172
  v_pk_fma_f32 v[40:41], v[18:19], v[50:51], v[40:41] op_sel:[0,1,0] op_sel_hi:[1,1,1]
  v_lshlrev_b32 v36, 16, v173
  v_and_b32 v37, 0xffff0000, v173
  v_pk_fma_f32 v[42:43], v[36:37], v[50:51], v[42:43] op_sel:[0,1,0] op_sel_hi:[1,1,1]
  v_lshlrev_b32 v18, 16, v174
  v_and_b32 v19, 0xffff0000, v174
  v_pk_fma_f32 v[44:45], v[18:19], v[50:51], v[44:45] op_sel:[0,1,0] op_sel_hi:[1,1,1]
  v_lshlrev_b32 v36, 16, v175
  v_and_b32 v37, 0xffff0000, v175
  v_pk_fma_f32 v[46:47], v[36:37], v[50:51], v[46:47] op_sel:[0,1,0] op_sel_hi:[1,1,1]
  s_waitcnt vmcnt(3)
  s_waitcnt lgkmcnt(0)
  v_lshlrev_b32 v18, 16, v176
  v_and_b32 v19, 0xffff0000, v176
  v_pk_fma_f32 v[40:41], v[18:19], v[52:53], v[40:41] op_sel:[0,0,0] op_sel_hi:[1,0,1]
  v_lshlrev_b32 v36, 16, v177
  v_and_b32 v37, 0xffff0000, v177
  v_pk_fma_f32 v[42:43], v[36:37], v[52:53], v[42:43] op_sel:[0,0,0] op_sel_hi:[1,0,1]
  v_lshlrev_b32 v18, 16, v178
  v_and_b32 v19, 0xffff0000, v178
  v_pk_fma_f32 v[44:45], v[18:19], v[52:53], v[44:45] op_sel:[0,0,0] op_sel_hi:[1,0,1]
  v_lshlrev_b32 v36, 16, v179
  v_and_b32 v37, 0xffff0000, v179
  v_pk_fma_f32 v[46:47], v[36:37], v[52:53], v[46:47] op_sel:[0,0,0] op_sel_hi:[1,0,1]
  s_waitcnt vmcnt(2)
  v_lshlrev_b32 v18, 16, v180
  v_and_b32 v19, 0xffff0000, v180
  v_pk_fma_f32 v[40:41], v[18:19], v[52:53], v[40:41] op_sel:[0,1,0] op_sel_hi:[1,1,1]
  v_lshlrev_b32 v36, 16, v181
  v_and_b32 v37, 0xffff0000, v181
  v_pk_fma_f32 v[42:43], v[36:37], v[52:53], v[42:43] op_sel:[0,1,0] op_sel_hi:[1,1,1]
  v_lshlrev_b32 v18, 16, v182
  v_and_b32 v19, 0xffff0000, v182
  v_pk_fma_f32 v[44:45], v[18:19], v[52:53], v[44:45] op_sel:[0,1,0] op_sel_hi:[1,1,1]
  v_lshlrev_b32 v36, 16, v183
  v_and_b32 v37, 0xffff0000, v183
  v_pk_fma_f32 v[46:47], v[36:37], v[52:53], v[46:47] op_sel:[0,1,0] op_sel_hi:[1,1,1]
  s_waitcnt vmcnt(1)
  v_lshlrev_b32 v18, 16, v184
  v_and_b32 v19, 0xffff0000, v184
  v_pk_fma_f32 v[40:41], v[18:19], v[54:55], v[40:41] op_sel:[0,0,0] op_sel_hi:[1,0,1]
  v_lshlrev_b32 v36, 16, v185
  v_and_b32 v37, 0xffff0000, v185
  v_pk_fma_f32 v[42:43], v[36:37], v[54:55], v[42:43] op_sel:[0,0,0] op_sel_hi:[1,0,1]
  v_lshlrev_b32 v18, 16, v186
  v_and_b32 v19, 0xffff0000, v186
  v_pk_fma_f32 v[44:45], v[18:19], v[54:55], v[44:45] op_sel:[0,0,0] op_sel_hi:[1,0,1]
  v_lshlrev_b32 v36, 16, v187
  v_and_b32 v37, 0xffff0000, v187
  v_pk_fma_f32 v[46:47], v[36:37], v[54:55], v[46:47] op_sel:[0,0,0] op_sel_hi:[1,0,1]
  s_waitcnt vmcnt(0)
  v_lshlrev_b32 v18, 16, v188
  v_and_b32 v19, 0xffff0000, v188
  v_pk_fma_f32 v[40:41], v[18:19], v[54:55], v[40:41] op_sel:[0,1,0] op_sel_hi:[1,1,1]
  v_lshlrev_b32 v36, 16, v189
  v_and_b32 v37, 0xffff0000, v189
  v_pk_fma_f32 v[42:43], v[36:37], v[54:55], v[42:43] op_sel:[0,1,0] op_sel_hi:[1,1,1]
  v_lshlrev_b32 v18, 16, v190
  v_and_b32 v19, 0xffff0000, v190
  v_pk_fma_f32 v[44:45], v[18:19], v[54:55], v[44:45] op_sel:[0,1,0] op_sel_hi:[1,1,1]
  v_lshlrev_b32 v36, 16, v191
  v_and_b32 v37, 0xffff0000, v191
  v_pk_fma_f32 v[46:47], v[36:37], v[54:55], v[46:47] op_sel:[0,1,0] op_sel_hi:[1,1,1]
  v_permlane32_swap_b32 v40, v41
  v_add_f32 v40, v40, v41
  v_permlane32_swap_b32 v42, v43
  v_add_f32 v42, v42, v43
  v_permlane32_swap_b32 v44, v45
  v_add_f32 v44, v44, v45
  v_permlane32_swap_b32 v46, v47
  v_add_f32 v46, v46, v47
  v_permlane16_swap_b32 v40, v42
  v_add_f32 v40, v40, v42
  v_permlane16_swap_b32 v44, v46
  v_add_f32 v44, v44, v46
  ds_write_b32 v8, v40 offset:24960
  ds_write_b32 v8, v44 offset:24976
  s_waitcnt lgkmcnt(0)
  s_mov_b64 exec, 1
  ds_add_rtn_u32 v18, v6, v7 offset:16
  s_waitcnt lgkmcnt(0)
  s_mov_b64 exec, -1
  v_readfirstlane_b32 s70, v18
  s_cmp_lg_u32 s70, 3
  s_cbranch_scc1 L_notlast
  ds_read_b64 v[32:33], v9 offset:24960
  ds_read_b64 v[34:35], v9 offset:25472
  ds_read_b64 v[36:37], v9 offset:25984
  ds_read_b64 v[38:39], v9 offset:26496
  s_waitcnt lgkmcnt(0)
  v_add_f32 v32, v32, v34
  v_add_f32 v33, v33, v35
  v_add_f32 v32, v32, v36
  v_add_f32 v33, v33, v37
  v_add_f32 v32, v32, v38
  v_add_f32 v33, v33, v39
  v_cvt_pk_bf16_f32 v32, v32, v33
  v_min_u32 v32, 0xfffffffe, v32
  buffer_store_dword v32, v10, s[44:47], s74 offen sc1
  ds_add_u32 v6, v7 offset:48
L_notlast:
  s_mul_i32 s41, s39, 16384
  s_add_u32 s41, s41, 76544
  v_lshrrev_b32 v14, 1, v0
  v_and_b32 v15, 1, v0
  v_lshlrev_b32 v15, 4, v15
  s_nop 0
  s_cmp_lt_u32 s35, 14
  s_cbranch_scc0 L_s_r1
  s_mov_b32 s68, 1
  s_mul_i32 s69, s34, 14
  s_add_u32 s69, s69, s35
  s_branch L_s_rs
L_s_r1:
  s_sub_u32 s69, s35, 16
  s_cmp_lt_u32 s69, 14
  s_cbranch_scc0 L_s_r2
  s_lshr_b32 s42, s69, 1
  s_cmp_lt_u32 s69, 7
  s_cselect_b32 s68, 3, 4
  s_branch L_s_rs
L_s_r2:
  s_and_b32 s69, s35, 1
  s_lshr_b32 s64, s35, 4
  s_lshl_b32 s64, s64, 1
  s_add_u32 s69, s69, s64
  s_lshl_b32 s64, s34, 2
  s_add_u32 s69, s69, s64
  s_cmp_lt_u32 s34, 7
  s_cselect_b32 s68, 2, 0
L_s_rs:
  s_cmp_eq_u32 s68, 0
  s_cbranch_scc1 L_FIN
  s_cmp_ge_u32 s68, 3
  s_cbranch_scc1 L_FIN
L_w_7:
  ds_read_b32 v18, v6 offset:48
  s_waitcnt lgkmcnt(0)
  v_readfirstlane_b32 s70, v18
  s_cmp_ge_u32 s70, 64
  s_cbranch_scc1 L_wd_8
  s_branch L_w_7
L_wd_8:
  s_cmp_eq_u32 s68, 1
  s_cbranch_scc0 L_sw_notup
  s_cmp_ge_u32 s39, 2
  s_cselect_b32 s60, s18, s16
  s_cselect_b32 s61, s19, s17
  s_mov_b32 s62, 1605632
  s_mov_b32 s63, 0x20000
  v_mul_u32_u24 v31, 3584, v14
  v_add_u32 v31, v31, v15
  s_and_b32 s64, s39, 1
  s_mul_i32 s64, s64, 802816
  s_lshl_b32 s65, s69, 5
  s_add_u32 s66, s64, s65
  s_add_u32 m0, s41, 0
  s_nop 0
  buffer_load_dwordx4 v31, s[60:63], s66 offen nt lds
  s_add_u32 s66, s66, 114688
  s_add_u32 m0, s41, 1024
  s_nop 0
  buffer_load_dwordx4 v31, s[60:63], s66 offen nt lds
  s_add_u32 s66, s66, 114688
  s_add_u32 m0, s41, 2048
  s_nop 0
  buffer_load_dwordx4 v31, s[60:63], s66 offen nt lds
  s_add_u32 s66, s66, 114688
  s_add_u32 m0, s41, 3072
  s_nop 0
  buffer_load_dwordx4 v31, s[60:63], s66 offen nt lds
  s_add_u32 s66, s66, 114688
  s_add_u32 m0, s41, 4096
  s_nop 0
  buffer_load_dwordx4 v31, s[60:63], s66 offen nt lds
  s_add_u32 s66, s66, 114688
  s_add_u32 m0, s41, 5120
  s_nop 0
  buffer_load_dwordx4 v31, s[60:63], s66 offen nt lds
  s_add_u32 s66, s66, 114688
  s_add_u32 m0, s41, 6144
  s_nop 0
  buffer_load_dwordx4 v31, s[60:63], s66 offen nt lds
  s_add_u32 s66, s66, 114688
  s_branch L_sw_wait
L_sw_notup:
  s_mov_b32 s60, s20
  s_mov_b32 s61, s21
  s_mov_b32 s62, 1605632
  s_mov_b32 s63, 0x20000
  v_mul_u32_u24 v31, 896, v14
  v_add_u32 v31, v31, v15
  s_mul_i32 s64, s39, 401408
  s_lshl_b32 s65, s69, 5
  s_add_u32 s66, s64, s65
  s_add_u32 m0, s41, 0
  s_nop 0
  buffer_load_dwordx4 v31, s[60:63], s66 offen nt lds
  s_add_u32 s66, s66, 28672
  s_add_u32 m0, s41, 1024
  s_nop 0
  buffer_load_dwordx4 v31, s[60:63], s66 offen nt lds
  s_add_u32 s66, s66, 28672
  s_add_u32 m0, s41, 2048
  s_nop 0
  buffer_load_dwordx4 v31, s[60:63], s66 offen nt lds
  s_add_u32 s66, s66, 28672
  s_add_u32 m0, s41, 3072
  s_nop 0
  buffer_load_dwordx4 v31, s[60:63], s66 offen nt lds
  s_add_u32 s66, s66, 28672
  s_add_u32 m0, s41, 4096
  s_nop 0
  buffer_load_dwordx4 v31, s[60:63], s66 offen nt lds
  s_add_u32 s66, s66, 28672
  s_add_u32 m0, s41, 5120
  s_nop 0
  buffer_load_dwordx4 v31, s[60:63], s66 offen nt lds
  s_add_u32 s66, s66, 28672
  s_add_u32 m0, s41, 6144
  s_nop 0
  buffer_load_dwordx4 v31, s[60:63], s66 offen nt lds
  s_add_u32 s66, s66, 28672
  s_add_u32 m0, s41, 7168
  s_nop 0
  buffer_load_dwordx4 v31, s[60:63], s66 offen nt lds
  s_add_u32 s66, s66, 28672
  s_add_u32 m0, s41, 8192
  s_nop 0
  buffer_load_dwordx4 v31, s[60:63], s66 offen nt lds
  s_add_u32 s66, s66, 28672
  s_add_u32 m0, s41, 9216
  s_nop 0
  buffer_load_dwordx4 v31, s[60:63], s66 offen nt lds
  s_add_u32 s66, s66, 28672
  s_add_u32 m0, s41, 10240
  s_nop 0
  buffer_load_dwordx4 v31, s[60:63], s66 offen nt lds
  s_add_u32 s66, s66, 28672
  s_add_u32 m0, s41, 11264
  s_nop 0
  buffer_load_dwordx4 v31, s[60:63], s66 offen nt lds
  s_add_u32 s66, s66, 28672
  s_add_u32 m0, s41, 12288
  s_nop 0
  buffer_load_dwordx4 v31, s[60:63], s66 offen nt lds
  s_add_u32 s66, s66, 28672
  s_add_u32 m0, s41, 13312
  s_nop 0
  buffer_load_dwordx4 v31, s[60:63], s66 offen nt lds
  s_add_u32 s66, s66, 28672
L_sw_wait:
  s_waitcnt vmcnt(0)
  s_waitcnt lgkmcnt(0)
  ds_add_u32 v6, v7 offset:44
  s_branch L_FIN
L_HPOST:
  s_mov_b32 s42, 0
  s_cmp_lt_u32 s35, 14
  s_cbranch_scc0 L_h_r1
  s_mov_b32 s68, 1
  s_mul_i32 s69, s34, 14
  s_add_u32 s69, s69, s35
  s_branch L_h_rs
L_h_r1:
  s_sub_u32 s69, s35, 16
  s_cmp_lt_u32 s69, 14
  s_cbranch_scc0 L_h_r2
  s_lshr_b32 s42, s69, 1
  s_cmp_lt_u32 s69, 7
  s_cselect_b32 s68, 3, 4
  s_branch L_h_rs
L_h_r2:
  s_and_b32 s69, s35, 1
  s_lshr_b32 s64, s35, 4
  s_lshl_b32 s64, s64, 1
  s_add_u32 s69, s69, s64
  s_lshl_b32 s64, s34, 2
  s_add_u32 s69, s69, s64
  s_cmp_lt_u32 s34, 7
  s_cselect_b32 s68, 2, 0
L_h_rs:
  v_lshrrev_b32 v24, 2, v0
  v_lshlrev_b32 v24, 7, v24
  v_and_b32 v25, 3, v0
  v_lshlrev_b32 v25, 2, v25
  v_add_u32 v12, v24, v25
  v_lshlrev_b32 v64, 7, v3
  v_lshlrev_b32 v25, 4, v4
  v_add_u32 v64, v64, v25
  v_mul_u32_u24 v65, 28672, v4
  v_lshlrev_b32 v25, 4, v3
  v_add_u32 v65, v65, v25
  v_lshrrev_b32 v66, 1, v3
  v_lshlrev_b32 v66, 7, v66
  v_lshlrev_b32 v25, 4, v4
  v_add_u32 v66, v66, v25
  v_and_b32 v25, 1, v3
  v_lshlrev_b32 v25, 3, v25
  v_add_u32 v66, v66, v25
  s_lshl_b32 s43, s36, 12
  s_lshl_b32 s64, s38, 11
  s_add_u32 s43, s43, s64
  s_lshl_b32 s64, s37, 4
  s_add_u32 s43, s43, s64
  s_add_u32 s43, s43, 327680
  s_lshl_b32 s72, s42, 12
  s_lshl_b32 s64, s36, 8
  s_add_u32 s72, s72, s64
  s_add_u32 s72, s72, 393216
  s_cmp_lg_u32 s40, 0
  s_cbranch_scc1 L_noclr
  v_mov_b32 v24, -1
  v_mov_b32 v25, -1
  v_mov_b32 v26, -1
  v_mov_b32 v27, -1
  s_mul_i32 s64, s2, 3072
  s_add_u32 s64, s64, 262144
  buffer_store_dwordx4 v[24:27], v9, s[44:47], s64 offen sc1
  buffer_store_dwordx4 v[24:27], v9, s[44:47], s64 offen offset:1024 sc1
  buffer_store_dwordx4 v[24:27], v9, s[44:47], s64 offen offset:2048 sc1
  s_waitcnt vmcnt(0)
  s_mov_b64 exec, 1
  global_atomic_add v86, v87, s[28:29] sc1
  s_mov_b64 exec, -1
L_noclr:
  s_cmp_eq_u32 s68, 1
  s_cbranch_scc1 L_pf_up
  s_cmp_eq_u32 s68, 2
  s_cbranch_scc1 L_pf_down
  s_cmp_eq_u32 s68, 3
  s_cbranch_scc1 L_pf_red
  s_branch L_pf_done
L_pf_up:
  s_branch L_pf_done
L_pf_down:
  v_and_b32 v24, 7, v0
  v_mul_u32_u24 v27, 10752, v24
  v_lshlrev_b32 v26, 4, v3
  v_add_u32 v27, v27, v26
  s_lshl_b32 s64, s69, 6
  s_add_u32 s66, s64, 13056
  s_mov_b32 s71, 262144
L_p_21:
  buffer_load_dwordx4 v[68:71], v27, s[44:47], s66 offen sc1
  s_waitcnt vmcnt(0)
  v_xor_b32 v60, s33, v69
  v_xor_b32 v28, s33, v71
  v_or_b32 v60, v60, v28
  v_cmp_ne_u32 vcc, 0, v60
  s_cbranch_vccz L_pd_22
  s_sub_u32 s71, s71, 1
  s_cmp_eq_u32 s71, 0
  s_cbranch_scc1 L_pd_22
  s_sleep 16
  s_branch L_p_21
L_pd_22:
  s_branch L_pf_done
L_pf_red:
  s_mov_b32 s56, s4
  s_mov_b32 s57, s5
  s_mov_b32 s58, 7168
  s_mov_b32 s59, 0x20000
  v_lshlrev_b32 v28, 2, v4
  v_and_b32 v29, 1, v3
  v_lshlrev_b32 v29, 1, v29
  v_add_u32 v28, v28, v29
  v_add_u32 v28, v28, v2
  v_lshlrev_b32 v31, 1, v28
  s_mul_i32 s64, s34, 896
  s_lshl_b32 s65, s69, 7
  s_add_u32 s64, s64, s65
  buffer_load_ushort v68, v31, s[56:59], s64 offen
  v_lshrrev_b32 v31, 1, v28
  v_lshlrev_b32 v31, 3, v31
  s_mul_i32 s64, s34, 10752
  s_lshl_b32 s65, s69, 8
  s_add_u32 s64, s64, s65
  s_add_u32 s64, s64, 7680
  s_mov_b32 s71, 262144
L_p_23:
  buffer_load_dwordx2 v[72:73], v31, s[44:47], s64 offen sc1
  s_waitcnt vmcnt(0)
  v_xor_b32 v60, s33, v73
  v_cmp_ne_u32 vcc, 0, v60
  s_cbranch_vccz L_pd_24
  s_sub_u32 s71, s71, 1
  s_cmp_eq_u32 s71, 0
  s_cbranch_scc1 L_pd_24
  s_sleep 16
  s_branch L_p_23
L_pd_24:
  v_lshlrev_b32 v68, 16, v68
  v_lshlrev_b32 v69, 16, v72
  v_and_b32 v70, 0xffff0000, v72
  v_cmp_eq_u32 vcc, 1, v2
  s_nop 1
  v_cndmask_b32 v69, v69, v70, vcc
L_pf_done:
  s_cmp_lg_u32 s40, 0
  s_cbranch_scc1 L_nosm
L_w_25:
  ds_read_b32 v50, v86 offset:8
  s_waitcnt lgkmcnt(0)
  v_readfirstlane_b32 s70, v50
  s_cmp_ge_u32 s70, 256
  s_cbranch_scc1 L_wd_26
  s_sleep 8
  s_branch L_w_25
L_wd_26:
  s_mov_b32 s71, 262144
L_dc_27:
  global_load_dword v24, v86, s[28:29] sc1
  s_waitcnt vmcnt(0)
  v_readfirstlane_b32 s64, v24
  s_cmp_ge_u32 s64, 256
  s_cbranch_scc1 L_dcd_28
  s_sub_u32 s71, s71, 1
  s_cmp_eq_u32 s71, 0
  s_cbranch_scc1 L_dcd_28
  s_sleep 64
  s_branch L_dc_27
L_dcd_28:
  v_mul_u32_u24 v208, 144, v0
  ds_read_b128 v[176:179], v208 offset:15744
  ds_read_b128 v[180:183], v208 offset:15760
  ds_read_b128 v[184:187], v208 offset:15776
  ds_read_b128 v[188:191], v208 offset:15792
  ds_read_b128 v[192:195], v208 offset:15808
  ds_read_b128 v[196:199], v208 offset:15824
  ds_read_b128 v[200:203], v208 offset:15840
  ds_read_b128 v[204:207], v208 offset:15856
  s_waitcnt lgkmcnt(0)
  v_cvt_pk_bf16_f32 v144, v176, v177
  v_mov_b32 v145, s33
  v_cvt_pk_bf16_f32 v146, v178, v179
  v_mov_b32 v147, s33
  v_cvt_pk_bf16_f32 v148, v180, v181
  v_mov_b32 v149, s33
  v_cvt_pk_bf16_f32 v150, v182, v183
  v_mov_b32 v151, s33
  v_cvt_pk_bf16_f32 v152, v184, v185
  v_mov_b32 v153, s33
  v_cvt_pk_bf16_f32 v154, v186, v187
  v_mov_b32 v155, s33
  v_cvt_pk_bf16_f32 v156, v188, v189
  v_mov_b32 v157, s33
  v_cvt_pk_bf16_f32 v158, v190, v191
  v_mov_b32 v159, s33
  v_cvt_pk_bf16_f32 v160, v192, v193
  v_mov_b32 v161, s33
  v_cvt_pk_bf16_f32 v162, v194, v195
  v_mov_b32 v163, s33
  v_cvt_pk_bf16_f32 v164, v196, v197
  v_mov_b32 v165, s33
  v_cvt_pk_bf16_f32 v166, v198, v199
  v_mov_b32 v167, s33
  v_cvt_pk_bf16_f32 v168, v200, v201
  v_mov_b32 v169, s33
  v_cvt_pk_bf16_f32 v170, v202, v203
  v_mov_b32 v171, s33
  v_cvt_pk_bf16_f32 v172, v204, v205
  v_mov_b32 v173, s33
  v_cvt_pk_bf16_f32 v174, v206, v207
  v_mov_b32 v175, s33
  s_lshl_b32 s64, s2, 13
  s_add_u32 s64, s64, 2097152
  buffer_store_dwordx4 v[144:147], v9, s[44:47], s64 offen sc1
  s_add_u32 s64, s64, 1024
  buffer_store_dwordx4 v[148:151], v9, s[44:47], s64 offen sc1
  s_add_u32 s64, s64, 1024
  buffer_store_dwordx4 v[152:155], v9, s[44:47], s64 offen sc1
  s_add_u32 s64, s64, 1024
  buffer_store_dwordx4 v[156:159], v9, s[44:47], s64 offen sc1
  s_add_u32 s64, s64, 1024
  buffer_store_dwordx4 v[160:163], v9, s[44:47], s64 offen sc1
  s_add_u32 s64, s64, 1024
  buffer_store_dwordx4 v[164:167], v9, s[44:47], s64 offen sc1
  s_add_u32 s64, s64, 1024
  buffer_store_dwordx4 v[168:171], v9, s[44:47], s64 offen sc1
  s_add_u32 s64, s64, 1024
  buffer_store_dwordx4 v[172:175], v9, s[44:47], s64 offen sc1
  s_add_u32 s64, s64, 1024
  s_xor_b32 s64, s2, 16
  s_lshl_b32 s64, s64, 13
  s_add_u32 s65, s64, 2097152
  s_add_u32 s64, s65, 8176
  s_mov_b64 exec, 1
  s_mov_b32 s71, 262144
L_p_29:
  buffer_load_dwordx2 v[176:177], v86, s[44:47], s64 offen sc1
  s_waitcnt vmcnt(0)
  v_xor_b32 v210, s33, v177
  v_cmp_ne_u32 vcc, 0, v210
  s_cbranch_vccz L_pd_30
  s_sub_u32 s71, s71, 1
  s_cmp_eq_u32 s71, 0
  s_cbranch_scc1 L_pd_30
  s_sleep 8
  s_branch L_p_29
L_pd_30:
  s_mov_b64 exec, -1
  s_mov_b32 s71, 262144
L_p_31:
  s_mov_b32 s64, s65
  buffer_load_dwordx4 v[176:179], v9, s[44:47], s64 offen sc1
  s_add_u32 s64, s64, 1024
  buffer_load_dwordx4 v[180:183], v9, s[44:47], s64 offen sc1
  s_add_u32 s64, s64, 1024
  buffer_load_dwordx4 v[184:187], v9, s[44:47], s64 offen sc1
  s_add_u32 s64, s64, 1024
  buffer_load_dwordx4 v[188:191], v9, s[44:47], s64 offen sc1
  s_add_u32 s64, s64, 1024
  buffer_load_dwordx4 v[192:195], v9, s[44:47], s64 offen sc1
  s_add_u32 s64, s64, 1024
  buffer_load_dwordx4 v[196:199], v9, s[44:47], s64 offen sc1
  s_add_u32 s64, s64, 1024
  buffer_load_dwordx4 v[200:203], v9, s[44:47], s64 offen sc1
  s_add_u32 s64, s64, 1024
  buffer_load_dwordx4 v[204:207], v9, s[44:47], s64 offen sc1
  s_add_u32 s64, s64, 1024
  s_waitcnt vmcnt(0)
  v_xor_b32 v210, s33, v177
  v_xor_b32 v211, s33, v179
  v_or_b32 v210, v210, v211
  v_xor_b32 v211, s33, v181
  v_xor_b32 v212, s33, v183
  v_or3_b32 v210, v210, v211, v212
  v_xor_b32 v211, s33, v185
  v_xor_b32 v212, s33, v187
  v_or3_b32 v210, v210, v211, v212
  v_xor_b32 v211, s33, v189
  v_xor_b32 v212, s33, v191
  v_or3_b32 v210, v210, v211, v212
  v_xor_b32 v211, s33, v193
  v_xor_b32 v212, s33, v195
  v_or3_b32 v210, v210, v211, v212
  v_xor_b32 v211, s33, v197
  v_xor_b32 v212, s33, v199
  v_or3_b32 v210, v210, v211, v212
  v_xor_b32 v211, s33, v201
  v_xor_b32 v212, s33, v203
  v_or3_b32 v210, v210, v211, v212
  v_xor_b32 v211, s33, v205
  v_xor_b32 v212, s33, v207
  v_or3_b32 v210, v210, v211, v212
  v_cmp_ne_u32 vcc, 0, v210
  s_cbranch_vccz L_pd_32
  s_sub_u32 s71, s71, 1
  s_cmp_eq_u32 s71, 0
  s_cbranch_scc1 L_pd_32
  s_sleep 8
  s_branch L_p_31
L_pd_32:
  v_lshlrev_b32 v208, 16, v144
  v_and_b32 v209, 0xffff0000, v144
  v_max_f32 v210, v208, v209
  v_lshlrev_b32 v208, 16, v146
  v_and_b32 v209, 0xffff0000, v146
  v_max3_f32 v210, v210, v208, v209
  v_lshlrev_b32 v208, 16, v148
  v_and_b32 v209, 0xffff0000, v148
  v_max3_f32 v210, v210, v208, v209
  v_lshlrev_b32 v208, 16, v150
  v_and_b32 v209, 0xffff0000, v150
  v_max3_f32 v210, v210, v208, v209
  v_lshlrev_b32 v208, 16, v152
  v_and_b32 v209, 0xffff0000, v152
  v_max3_f32 v210, v210, v208, v209
  v_lshlrev_b32 v208, 16, v154
  v_and_b32 v209, 0xffff0000, v154
  v_max3_f32 v210, v210, v208, v209
  v_lshlrev_b32 v208, 16, v156
  v_and_b32 v209, 0xffff0000, v156
  v_max3_f32 v210, v210, v208, v209
  v_lshlrev_b32 v208, 16, v158
  v_and_b32 v209, 0xffff0000, v158
  v_max3_f32 v210, v210, v208, v209
  v_lshlrev_b32 v208, 16, v160
  v_and_b32 v209, 0xffff0000, v160
  v_max3_f32 v210, v210, v208, v209
  v_lshlrev_b32 v208, 16, v162
  v_and_b32 v209, 0xffff0000, v162
  v_max3_f32 v210, v210, v208, v209
  v_lshlrev_b32 v208, 16, v164
  v_and_b32 v209, 0xffff0000, v164
  v_max3_f32 v210, v210, v208, v209
  v_lshlrev_b32 v208, 16, v166
  v_and_b32 v209, 0xffff0000, v166
  v_max3_f32 v210, v210, v208, v209
  v_lshlrev_b32 v208, 16, v168
  v_and_b32 v209, 0xffff0000, v168
  v_max3_f32 v210, v210, v208, v209
  v_lshlrev_b32 v208, 16, v170
  v_and_b32 v209, 0xffff0000, v170
  v_max3_f32 v210, v210, v208, v209
  v_lshlrev_b32 v208, 16, v172
  v_and_b32 v209, 0xffff0000, v172
  v_max3_f32 v210, v210, v208, v209
  v_lshlrev_b32 v208, 16, v174
  v_and_b32 v209, 0xffff0000, v174
  v_max3_f32 v210, v210, v208, v209
  v_lshlrev_b32 v208, 16, v176
  v_and_b32 v209, 0xffff0000, v176
  v_max3_f32 v210, v210, v208, v209
  v_lshlrev_b32 v208, 16, v178
  v_and_b32 v209, 0xffff0000, v178
  v_max3_f32 v210, v210, v208, v209
  v_lshlrev_b32 v208, 16, v180
  v_and_b32 v209, 0xffff0000, v180
  v_max3_f32 v210, v210, v208, v209
  v_lshlrev_b32 v208, 16, v182
  v_and_b32 v209, 0xffff0000, v182
  v_max3_f32 v210, v210, v208, v209
  v_lshlrev_b32 v208, 16, v184
  v_and_b32 v209, 0xffff0000, v184
  v_max3_f32 v210, v210, v208, v209
  v_lshlrev_b32 v208, 16, v186
  v_and_b32 v209, 0xffff0000, v186
  v_max3_f32 v210, v210, v208, v209
  v_lshlrev_b32 v208, 16, v188
  v_and_b32 v209, 0xffff0000, v188
  v_max3_f32 v210, v210, v208, v209
  v_lshlrev_b32 v208, 16, v190
  v_and_b32 v209, 0xffff0000, v190
  v_max3_f32 v210, v210, v208, v209
  v_lshlrev_b32 v208, 16, v192
  v_and_b32 v209, 0xffff0000, v192
  v_max3_f32 v210, v210, v208, v209
  v_lshlrev_b32 v208, 16, v194
  v_and_b32 v209, 0xffff0000, v194
  v_max3_f32 v210, v210, v208, v209
  v_lshlrev_b32 v208, 16, v196
  v_and_b32 v209, 0xffff0000, v196
  v_max3_f32 v210, v210, v208, v209
  v_lshlrev_b32 v208, 16, v198
  v_and_b32 v209, 0xffff0000, v198
  v_max3_f32 v210, v210, v208, v209
  v_lshlrev_b32 v208, 16, v200
  v_and_b32 v209, 0xffff0000, v200
  v_max3_f32 v210, v210, v208, v209
  v_lshlrev_b32 v208, 16, v202
  v_and_b32 v209, 0xffff0000, v202
  v_max3_f32 v210, v210, v208, v209
  v_lshlrev_b32 v208, 16, v204
  v_and_b32 v209, 0xffff0000, v204
  v_max3_f32 v210, v210, v208, v209
  v_lshlrev_b32 v208, 16, v206
  v_and_b32 v209, 0xffff0000, v206
  v_max3_f32 v210, v210, v208, v209
  s_nop 1
  v_max_f32_dpp v210, v210, v210 quad_perm:[1,0,3,2] row_mask:0xf bank_mask:0xf
  s_nop 1
  v_max_f32_dpp v210, v210, v210 quad_perm:[2,3,0,1] row_mask:0xf bank_mask:0xf
  s_nop 1
  v_max_f32_dpp v210, v210, v210 row_half_mirror row_mask:0xf bank_mask:0xf
  s_nop 1
  v_max_f32_dpp v210, v210, v210 row_mirror row_mask:0xf bank_mask:0xf
  v_mov_b32 v211, v210
  s_nop 1
  v_permlane16_swap_b32 v210, v211
  v_max_f32 v210, v210, v211
  v_mov_b32 v211, v210
  s_nop 1
  v_permlane32_swap_b32 v210, v211
  v_max_f32 v210, v210, v211
  s_mov_b32 s64, 0x3db8aa3b
  v_lshlrev_b32 v208, 16, v144
  v_and_b32 v209, 0xffff0000, v144
  v_sub_f32 v208, v208, v210
  v_sub_f32 v209, v209, v210
  v_mul_f32 v208, s64, v208
  v_mul_f32 v209, s64, v209
  v_exp_f32 v208, v208
  v_exp_f32 v209, v209
  s_nop 0
  v_add_f32 v212, v208, v209
  v_lshlrev_b32 v208, 16, v146
  v_and_b32 v209, 0xffff0000, v146
  v_sub_f32 v208, v208, v210
  v_sub_f32 v209, v209, v210
  v_mul_f32 v208, s64, v208
  v_mul_f32 v209, s64, v209
  v_exp_f32 v208, v208
  v_exp_f32 v209, v209
  v_add_f32 v212, v212, v208
  v_add_f32 v212, v212, v209
  v_lshlrev_b32 v208, 16, v148
  v_and_b32 v209, 0xffff0000, v148
  v_sub_f32 v208, v208, v210
  v_sub_f32 v209, v209, v210
  v_mul_f32 v208, s64, v208
  v_mul_f32 v209, s64, v209
  v_exp_f32 v208, v208
  v_exp_f32 v209, v209
  v_add_f32 v212, v212, v208
  v_add_f32 v212, v212, v209
  v_lshlrev_b32 v208, 16, v150
  v_and_b32 v209, 0xffff0000, v150
  v_sub_f32 v208, v208, v210
  v_sub_f32 v209, v209, v210
  v_mul_f32 v208, s64, v208
  v_mul_f32 v209, s64, v209
  v_exp_f32 v208, v208
  v_exp_f32 v209, v209
  v_add_f32 v212, v212, v208
  v_add_f32 v212, v212, v209
  v_lshlrev_b32 v208, 16, v152
  v_and_b32 v209, 0xffff0000, v152
  v_sub_f32 v208, v208, v210
  v_sub_f32 v209, v209, v210
  v_mul_f32 v208, s64, v208
  v_mul_f32 v209, s64, v209
  v_exp_f32 v208, v208
  v_exp_f32 v209, v209
  v_add_f32 v212, v212, v208
  v_add_f32 v212, v212, v209
  v_lshlrev_b32 v208, 16, v154
  v_and_b32 v209, 0xffff0000, v154
  v_sub_f32 v208, v208, v210
  v_sub_f32 v209, v209, v210
  v_mul_f32 v208, s64, v208
  v_mul_f32 v209, s64, v209
  v_exp_f32 v208, v208
  v_exp_f32 v209, v209
  v_add_f32 v212, v212, v208
  v_add_f32 v212, v212, v209
  v_lshlrev_b32 v208, 16, v156
  v_and_b32 v209, 0xffff0000, v156
  v_sub_f32 v208, v208, v210
  v_sub_f32 v209, v209, v210
  v_mul_f32 v208, s64, v208
  v_mul_f32 v209, s64, v209
  v_exp_f32 v208, v208
  v_exp_f32 v209, v209
  v_add_f32 v212, v212, v208
  v_add_f32 v212, v212, v209
  v_lshlrev_b32 v208, 16, v158
  v_and_b32 v209, 0xffff0000, v158
  v_sub_f32 v208, v208, v210
  v_sub_f32 v209, v209, v210
  v_mul_f32 v208, s64, v208
  v_mul_f32 v209, s64, v209
  v_exp_f32 v208, v208
  v_exp_f32 v209, v209
  v_add_f32 v212, v212, v208
  v_add_f32 v212, v212, v209
  v_lshlrev_b32 v208, 16, v160
  v_and_b32 v209, 0xffff0000, v160
  v_sub_f32 v208, v208, v210
  v_sub_f32 v209, v209, v210
  v_mul_f32 v208, s64, v208
  v_mul_f32 v209, s64, v209
  v_exp_f32 v208, v208
  v_exp_f32 v209, v209
  v_add_f32 v212, v212, v208
  v_add_f32 v212, v212, v209
  v_lshlrev_b32 v208, 16, v162
  v_and_b32 v209, 0xffff0000, v162
  v_sub_f32 v208, v208, v210
  v_sub_f32 v209, v209, v210
  v_mul_f32 v208, s64, v208
  v_mul_f32 v209, s64, v209
  v_exp_f32 v208, v208
  v_exp_f32 v209, v209
  v_add_f32 v212, v212, v208
  v_add_f32 v212, v212, v209
  v_lshlrev_b32 v208, 16, v164
  v_and_b32 v209, 0xffff0000, v164
  v_sub_f32 v208, v208, v210
  v_sub_f32 v209, v209, v210
  v_mul_f32 v208, s64, v208
  v_mul_f32 v209, s64, v209
  v_exp_f32 v208, v208
  v_exp_f32 v209, v209
  v_add_f32 v212, v212, v208
  v_add_f32 v212, v212, v209
  v_lshlrev_b32 v208, 16, v166
  v_and_b32 v209, 0xffff0000, v166
  v_sub_f32 v208, v208, v210
  v_sub_f32 v209, v209, v210
  v_mul_f32 v208, s64, v208
  v_mul_f32 v209, s64, v209
  v_exp_f32 v208, v208
  v_exp_f32 v209, v209
  v_add_f32 v212, v212, v208
  v_add_f32 v212, v212, v209
  v_lshlrev_b32 v208, 16, v168
  v_and_b32 v209, 0xffff0000, v168
  v_sub_f32 v208, v208, v210
  v_sub_f32 v209, v209, v210
  v_mul_f32 v208, s64, v208
  v_mul_f32 v209, s64, v209
  v_exp_f32 v208, v208
  v_exp_f32 v209, v209
  v_add_f32 v212, v212, v208
  v_add_f32 v212, v212, v209
  v_lshlrev_b32 v208, 16, v170
  v_and_b32 v209, 0xffff0000, v170
  v_sub_f32 v208, v208, v210
  v_sub_f32 v209, v209, v210
  v_mul_f32 v208, s64, v208
  v_mul_f32 v209, s64, v209
  v_exp_f32 v208, v208
  v_exp_f32 v209, v209
  v_add_f32 v212, v212, v208
  v_add_f32 v212, v212, v209
  v_lshlrev_b32 v208, 16, v172
  v_and_b32 v209, 0xffff0000, v172
  v_sub_f32 v208, v208, v210
  v_sub_f32 v209, v209, v210
  v_mul_f32 v208, s64, v208
  v_mul_f32 v209, s64, v209
  v_exp_f32 v208, v208
  v_exp_f32 v209, v209
  v_add_f32 v212, v212, v208
  v_add_f32 v212, v212, v209
  v_lshlrev_b32 v208, 16, v174
  v_and_b32 v209, 0xffff0000, v174
  v_sub_f32 v208, v208, v210
  v_sub_f32 v209, v209, v210
  v_mul_f32 v208, s64, v208
  v_mul_f32 v209, s64, v209
  v_exp_f32 v208, v208
  v_exp_f32 v209, v209
  v_add_f32 v212, v212, v208
  v_add_f32 v212, v212, v209
  v_lshlrev_b32 v208, 16, v176
  v_and_b32 v209, 0xffff0000, v176
  v_sub_f32 v208, v208, v210
  v_sub_f32 v209, v209, v210
  v_mul_f32 v208, s64, v208
  v_mul_f32 v209, s64, v209
  v_exp_f32 v208, v208
  v_exp_f32 v209, v209
  v_add_f32 v212, v212, v208
  v_add_f32 v212, v212, v209
  v_lshlrev_b32 v208, 16, v178
  v_and_b32 v209, 0xffff0000, v178
  v_sub_f32 v208, v208, v210
  v_sub_f32 v209, v209, v210
  v_mul_f32 v208, s64, v208
  v_mul_f32 v209, s64, v209
  v_exp_f32 v208, v208
  v_exp_f32 v209, v209
  v_add_f32 v212, v212, v208
  v_add_f32 v212, v212, v209
  v_lshlrev_b32 v208, 16, v180
  v_and_b32 v209, 0xffff0000, v180
  v_sub_f32 v208, v208, v210
  v_sub_f32 v209, v209, v210
  v_mul_f32 v208, s64, v208
  v_mul_f32 v209, s64, v209
  v_exp_f32 v208, v208
  v_exp_f32 v209, v209
  v_add_f32 v212, v212, v208
  v_add_f32 v212, v212, v209
  v_lshlrev_b32 v208, 16, v182
  v_and_b32 v209, 0xffff0000, v182
  v_sub_f32 v208, v208, v210
  v_sub_f32 v209, v209, v210
  v_mul_f32 v208, s64, v208
  v_mul_f32 v209, s64, v209
  v_exp_f32 v208, v208
  v_exp_f32 v209, v209
  v_add_f32 v212, v212, v208
  v_add_f32 v212, v212, v209
  v_lshlrev_b32 v208, 16, v184
  v_and_b32 v209, 0xffff0000, v184
  v_sub_f32 v208, v208, v210
  v_sub_f32 v209, v209, v210
  v_mul_f32 v208, s64, v208
  v_mul_f32 v209, s64, v209
  v_exp_f32 v208, v208
  v_exp_f32 v209, v209
  v_add_f32 v212, v212, v208
  v_add_f32 v212, v212, v209
  v_lshlrev_b32 v208, 16, v186
  v_and_b32 v209, 0xffff0000, v186
  v_sub_f32 v208, v208, v210
  v_sub_f32 v209, v209, v210
  v_mul_f32 v208, s64, v208
  v_mul_f32 v209, s64, v209
  v_exp_f32 v208, v208
  v_exp_f32 v209, v209
  v_add_f32 v212, v212, v208
  v_add_f32 v212, v212, v209
  v_lshlrev_b32 v208, 16, v188
  v_and_b32 v209, 0xffff0000, v188
  v_sub_f32 v208, v208, v210
  v_sub_f32 v209, v209, v210
  v_mul_f32 v208, s64, v208
  v_mul_f32 v209, s64, v209
  v_exp_f32 v208, v208
  v_exp_f32 v209, v209
  v_add_f32 v212, v212, v208
  v_add_f32 v212, v212, v209
  v_lshlrev_b32 v208, 16, v190
  v_and_b32 v209, 0xffff0000, v190
  v_sub_f32 v208, v208, v210
  v_sub_f32 v209, v209, v210
  v_mul_f32 v208, s64, v208
  v_mul_f32 v209, s64, v209
  v_exp_f32 v208, v208
  v_exp_f32 v209, v209
  v_add_f32 v212, v212, v208
  v_add_f32 v212, v212, v209
  v_lshlrev_b32 v208, 16, v192
  v_and_b32 v209, 0xffff0000, v192
  v_sub_f32 v208, v208, v210
  v_sub_f32 v209, v209, v210
  v_mul_f32 v208, s64, v208
  v_mul_f32 v209, s64, v209
  v_exp_f32 v208, v208
  v_exp_f32 v209, v209
  v_add_f32 v212, v212, v208
  v_add_f32 v212, v212, v209
  v_lshlrev_b32 v208, 16, v194
  v_and_b32 v209, 0xffff0000, v194
  v_sub_f32 v208, v208, v210
  v_sub_f32 v209, v209, v210
  v_mul_f32 v208, s64, v208
  v_mul_f32 v209, s64, v209
  v_exp_f32 v208, v208
  v_exp_f32 v209, v209
  v_add_f32 v212, v212, v208
  v_add_f32 v212, v212, v209
  v_lshlrev_b32 v208, 16, v196
  v_and_b32 v209, 0xffff0000, v196
  v_sub_f32 v208, v208, v210
  v_sub_f32 v209, v209, v210
  v_mul_f32 v208, s64, v208
  v_mul_f32 v209, s64, v209
  v_exp_f32 v208, v208
  v_exp_f32 v209, v209
  v_add_f32 v212, v212, v208
  v_add_f32 v212, v212, v209
  v_lshlrev_b32 v208, 16, v198
  v_and_b32 v209, 0xffff0000, v198
  v_sub_f32 v208, v208, v210
  v_sub_f32 v209, v209, v210
  v_mul_f32 v208, s64, v208
  v_mul_f32 v209, s64, v209
  v_exp_f32 v208, v208
  v_exp_f32 v209, v209
  v_add_f32 v212, v212, v208
  v_add_f32 v212, v212, v209
  v_lshlrev_b32 v208, 16, v200
  v_and_b32 v209, 0xffff0000, v200
  v_sub_f32 v208, v208, v210
  v_sub_f32 v209, v209, v210
  v_mul_f32 v208, s64, v208
  v_mul_f32 v209, s64, v209
  v_exp_f32 v208, v208
  v_exp_f32 v209, v209
  v_add_f32 v212, v212, v208
  v_add_f32 v212, v212, v209
  v_lshlrev_b32 v208, 16, v202
  v_and_b32 v209, 0xffff0000, v202
  v_sub_f32 v208, v208, v210
  v_sub_f32 v209, v209, v210
  v_mul_f32 v208, s64, v208
  v_mul_f32 v209, s64, v209
  v_exp_f32 v208, v208
  v_exp_f32 v209, v209
  v_add_f32 v212, v212, v208
  v_add_f32 v212, v212, v209
  v_lshlrev_b32 v208, 16, v204
  v_and_b32 v209, 0xffff0000, v204
  v_sub_f32 v208, v208, v210
  v_sub_f32 v209, v209, v210
  v_mul_f32 v208, s64, v208
  v_mul_f32 v209, s64, v209
  v_exp_f32 v208, v208
  v_exp_f32 v209, v209
  v_add_f32 v212, v212, v208
  v_add_f32 v212, v212, v209
  v_lshlrev_b32 v208, 16, v206
  v_and_b32 v209, 0xffff0000, v206
  v_sub_f32 v208, v208, v210
  v_sub_f32 v209, v209, v210
  v_mul_f32 v208, s64, v208
  v_mul_f32 v209, s64, v209
  v_exp_f32 v208, v208
  v_exp_f32 v209, v209
  v_add_f32 v212, v212, v208
  v_add_f32 v212, v212, v209
  s_nop 1
  v_add_f32_dpp v212, v212, v212 quad_perm:[1,0,3,2] row_mask:0xf bank_mask:0xf
  s_nop 1
  v_add_f32_dpp v212, v212, v212 quad_perm:[2,3,0,1] row_mask:0xf bank_mask:0xf
  s_nop 1
  v_add_f32_dpp v212, v212, v212 row_half_mirror row_mask:0xf bank_mask:0xf
  s_nop 1
  v_add_f32_dpp v212, v212, v212 row_mirror row_mask:0xf bank_mask:0xf
  v_mov_b32 v211, v212
  s_nop 1
  v_permlane16_swap_b32 v212, v211
  v_add_f32 v212, v212, v211
  v_mov_b32 v211, v212
  s_nop 1
  v_permlane32_swap_b32 v212, v211
  v_add_f32 v212, v212, v211
  v_rcp_f32 v213, v212
  s_nop 0
  v_fma_f32 v211, -v212, v213, 1.0
  v_fma_f32 v213, v211, v213, v213
  v_lshrrev_b32 v214, 4, v0
  v_and_b32 v214, 1, v214
  v_lshlrev_b32 v214, 3, v214
  v_lshrrev_b32 v215, 5, v0
  v_add_u32 v214, v214, v215
  v_mul_u32_u24 v214, 1040, v214
  v_lshrrev_b32 v215, 3, v0
  v_and_b32 v215, 1, v215
  v_lshrrev_b32 v216, 1, v0
  v_and_b32 v216, 2, v216
  v_or_b32 v215, v215, v216
  v_lshlrev_b32 v216, 1, v0
  v_and_b32 v216, 4, v216
  v_or_b32 v215, v215, v216
  v_lshlrev_b32 v216, 3, v0
  v_and_b32 v216, 8, v216
  v_or_b32 v215, v215, v216
  s_lshl_b32 s65, s38, 9
  v_mov_b32 v217, v215
  v_mov_b32 v218, v215
  v_add_u32 v219, s65, v214
  s_xor_b32 s65, s65, 512
  v_add_u32 v220, s65, v214
  v_and_b32 v216, 127, v217
  v_lshl_add_u32 v215, v216, 2, v219
  v_add_u32 v217, 16, v217
  v_lshlrev_b32 v208, 16, v144
  v_and_b32 v209, 0xffff0000, v144
  v_sub_f32 v208, v208, v210
  v_sub_f32 v209, v209, v210
  v_mul_f32 v208, s64, v208
  v_mul_f32 v209, s64, v209
  v_exp_f32 v208, v208
  v_exp_f32 v209, v209
  v_mul_f32 v208, v208, v213
  v_mul_f32 v209, v209, v213
  v_cvt_pk_bf16_f32 v211, v208, v209
  v_lshlrev_b32 v208, 16, v211
  v_and_b32 v209, 0xffff0000, v211
  ds_write_b32 v215, v208 offset:27008
  ds_write_b32 v215, v209 offset:29088
  v_lshlrev_b32 v208, 16, v146
  v_and_b32 v209, 0xffff0000, v146
  v_sub_f32 v208, v208, v210
  v_sub_f32 v209, v209, v210
  v_mul_f32 v208, s64, v208
  v_mul_f32 v209, s64, v209
  v_exp_f32 v208, v208
  v_exp_f32 v209, v209
  v_mul_f32 v208, v208, v213
  v_mul_f32 v209, v209, v213
  v_cvt_pk_bf16_f32 v211, v208, v209
  v_lshlrev_b32 v208, 16, v211
  v_and_b32 v209, 0xffff0000, v211
  ds_write_b32 v215, v208 offset:31168
  ds_write_b32 v215, v209 offset:33248
  v_and_b32 v216, 127, v217
  v_lshl_add_u32 v215, v216, 2, v219
  v_add_u32 v217, 16, v217
  v_lshlrev_b32 v208, 16, v148
  v_and_b32 v209, 0xffff0000, v148
  v_sub_f32 v208, v208, v210
  v_sub_f32 v209, v209, v210
  v_mul_f32 v208, s64, v208
  v_mul_f32 v209, s64, v209
  v_exp_f32 v208, v208
  v_exp_f32 v209, v209
  v_mul_f32 v208, v208, v213
  v_mul_f32 v209, v209, v213
  v_cvt_pk_bf16_f32 v211, v208, v209
  v_lshlrev_b32 v208, 16, v211
  v_and_b32 v209, 0xffff0000, v211
  ds_write_b32 v215, v208 offset:27008
  ds_write_b32 v215, v209 offset:29088
  v_lshlrev_b32 v208, 16, v150
  v_and_b32 v209, 0xffff0000, v150
  v_sub_f32 v208, v208, v210
  v_sub_f32 v209, v209, v210
  v_mul_f32 v208, s64, v208
  v_mul_f32 v209, s64, v209
  v_exp_f32 v208, v208
  v_exp_f32 v209, v209
  v_mul_f32 v208, v208, v213
  v_mul_f32 v209, v209, v213
  v_cvt_pk_bf16_f32 v211, v208, v209
  v_lshlrev_b32 v208, 16, v211
  v_and_b32 v209, 0xffff0000, v211
  ds_write_b32 v215, v208 offset:31168
  ds_write_b32 v215, v209 offset:33248
  v_and_b32 v216, 127, v217
  v_lshl_add_u32 v215, v216, 2, v219
  v_add_u32 v217, 16, v217
  v_lshlrev_b32 v208, 16, v152
  v_and_b32 v209, 0xffff0000, v152
  v_sub_f32 v208, v208, v210
  v_sub_f32 v209, v209, v210
  v_mul_f32 v208, s64, v208
  v_mul_f32 v209, s64, v209
  v_exp_f32 v208, v208
  v_exp_f32 v209, v209
  v_mul_f32 v208, v208, v213
  v_mul_f32 v209, v209, v213
  v_cvt_pk_bf16_f32 v211, v208, v209
  v_lshlrev_b32 v208, 16, v211
  v_and_b32 v209, 0xffff0000, v211
  ds_write_b32 v215, v208 offset:27008
  ds_write_b32 v215, v209 offset:29088
  v_lshlrev_b32 v208, 16, v154
  v_and_b32 v209, 0xffff0000, v154
  v_sub_f32 v208, v208, v210
  v_sub_f32 v209, v209, v210
  v_mul_f32 v208, s64, v208
  v_mul_f32 v209, s64, v209
  v_exp_f32 v208, v208
  v_exp_f32 v209, v209
  v_mul_f32 v208, v208, v213
  v_mul_f32 v209, v209, v213
  v_cvt_pk_bf16_f32 v211, v208, v209
  v_lshlrev_b32 v208, 16, v211
  v_and_b32 v209, 0xffff0000, v211
  ds_write_b32 v215, v208 offset:31168
  ds_write_b32 v215, v209 offset:33248
  v_and_b32 v216, 127, v217
  v_lshl_add_u32 v215, v216, 2, v219
  v_add_u32 v217, 16, v217
  v_lshlrev_b32 v208, 16, v156
  v_and_b32 v209, 0xffff0000, v156
  v_sub_f32 v208, v208, v210
  v_sub_f32 v209, v209, v210
  v_mul_f32 v208, s64, v208
  v_mul_f32 v209, s64, v209
  v_exp_f32 v208, v208
  v_exp_f32 v209, v209
  v_mul_f32 v208, v208, v213
  v_mul_f32 v209, v209, v213
  v_cvt_pk_bf16_f32 v211, v208, v209
  v_lshlrev_b32 v208, 16, v211
  v_and_b32 v209, 0xffff0000, v211
  ds_write_b32 v215, v208 offset:27008
  ds_write_b32 v215, v209 offset:29088
  v_lshlrev_b32 v208, 16, v158
  v_and_b32 v209, 0xffff0000, v158
  v_sub_f32 v208, v208, v210
  v_sub_f32 v209, v209, v210
  v_mul_f32 v208, s64, v208
  v_mul_f32 v209, s64, v209
  v_exp_f32 v208, v208
  v_exp_f32 v209, v209
  v_mul_f32 v208, v208, v213
  v_mul_f32 v209, v209, v213
  v_cvt_pk_bf16_f32 v211, v208, v209
  v_lshlrev_b32 v208, 16, v211
  v_and_b32 v209, 0xffff0000, v211
  ds_write_b32 v215, v208 offset:31168
  ds_write_b32 v215, v209 offset:33248
  v_and_b32 v216, 127, v217
  v_lshl_add_u32 v215, v216, 2, v219
  v_add_u32 v217, 16, v217
  v_lshlrev_b32 v208, 16, v160
  v_and_b32 v209, 0xffff0000, v160
  v_sub_f32 v208, v208, v210
  v_sub_f32 v209, v209, v210
  v_mul_f32 v208, s64, v208
  v_mul_f32 v209, s64, v209
  v_exp_f32 v208, v208
  v_exp_f32 v209, v209
  v_mul_f32 v208, v208, v213
  v_mul_f32 v209, v209, v213
  v_cvt_pk_bf16_f32 v211, v208, v209
  v_lshlrev_b32 v208, 16, v211
  v_and_b32 v209, 0xffff0000, v211
  ds_write_b32 v215, v208 offset:27008
  ds_write_b32 v215, v209 offset:29088
  v_lshlrev_b32 v208, 16, v162
  v_and_b32 v209, 0xffff0000, v162
  v_sub_f32 v208, v208, v210
  v_sub_f32 v209, v209, v210
  v_mul_f32 v208, s64, v208
  v_mul_f32 v209, s64, v209
  v_exp_f32 v208, v208
  v_exp_f32 v209, v209
  v_mul_f32 v208, v208, v213
  v_mul_f32 v209, v209, v213
  v_cvt_pk_bf16_f32 v211, v208, v209
  v_lshlrev_b32 v208, 16, v211
  v_and_b32 v209, 0xffff0000, v211
  ds_write_b32 v215, v208 offset:31168
  ds_write_b32 v215, v209 offset:33248
  v_and_b32 v216, 127, v217
  v_lshl_add_u32 v215, v216, 2, v219
  v_add_u32 v217, 16, v217
  v_lshlrev_b32 v208, 16, v164
  v_and_b32 v209, 0xffff0000, v164
  v_sub_f32 v208, v208, v210
  v_sub_f32 v209, v209, v210
  v_mul_f32 v208, s64, v208
  v_mul_f32 v209, s64, v209
  v_exp_f32 v208, v208
  v_exp_f32 v209, v209
  v_mul_f32 v208, v208, v213
  v_mul_f32 v209, v209, v213
  v_cvt_pk_bf16_f32 v211, v208, v209
  v_lshlrev_b32 v208, 16, v211
  v_and_b32 v209, 0xffff0000, v211
  ds_write_b32 v215, v208 offset:27008
  ds_write_b32 v215, v209 offset:29088
  v_lshlrev_b32 v208, 16, v166
  v_and_b32 v209, 0xffff0000, v166
  v_sub_f32 v208, v208, v210
  v_sub_f32 v209, v209, v210
  v_mul_f32 v208, s64, v208
  v_mul_f32 v209, s64, v209
  v_exp_f32 v208, v208
  v_exp_f32 v209, v209
  v_mul_f32 v208, v208, v213
  v_mul_f32 v209, v209, v213
  v_cvt_pk_bf16_f32 v211, v208, v209
  v_lshlrev_b32 v208, 16, v211
  v_and_b32 v209, 0xffff0000, v211
  ds_write_b32 v215, v208 offset:31168
  ds_write_b32 v215, v209 offset:33248
  v_and_b32 v216, 127, v217
  v_lshl_add_u32 v215, v216, 2, v219
  v_add_u32 v217, 16, v217
  v_lshlrev_b32 v208, 16, v168
  v_and_b32 v209, 0xffff0000, v168
  v_sub_f32 v208, v208, v210
  v_sub_f32 v209, v209, v210
  v_mul_f32 v208, s64, v208
  v_mul_f32 v209, s64, v209
  v_exp_f32 v208, v208
  v_exp_f32 v209, v209
  v_mul_f32 v208, v208, v213
  v_mul_f32 v209, v209, v213
  v_cvt_pk_bf16_f32 v211, v208, v209
  v_lshlrev_b32 v208, 16, v211
  v_and_b32 v209, 0xffff0000, v211
  ds_write_b32 v215, v208 offset:27008
  ds_write_b32 v215, v209 offset:29088
  v_lshlrev_b32 v208, 16, v170
  v_and_b32 v209, 0xffff0000, v170
  v_sub_f32 v208, v208, v210
  v_sub_f32 v209, v209, v210
  v_mul_f32 v208, s64, v208
  v_mul_f32 v209, s64, v209
  v_exp_f32 v208, v208
  v_exp_f32 v209, v209
  v_mul_f32 v208, v208, v213
  v_mul_f32 v209, v209, v213
  v_cvt_pk_bf16_f32 v211, v208, v209
  v_lshlrev_b32 v208, 16, v211
  v_and_b32 v209, 0xffff0000, v211
  ds_write_b32 v215, v208 offset:31168
  ds_write_b32 v215, v209 offset:33248
  v_and_b32 v216, 127, v217
  v_lshl_add_u32 v215, v216, 2, v219
  v_add_u32 v217, 16, v217
  v_lshlrev_b32 v208, 16, v172
  v_and_b32 v209, 0xffff0000, v172
  v_sub_f32 v208, v208, v210
  v_sub_f32 v209, v209, v210
  v_mul_f32 v208, s64, v208
  v_mul_f32 v209, s64, v209
  v_exp_f32 v208, v208
  v_exp_f32 v209, v209
  v_mul_f32 v208, v208, v213
  v_mul_f32 v209, v209, v213
  v_cvt_pk_bf16_f32 v211, v208, v209
  v_lshlrev_b32 v208, 16, v211
  v_and_b32 v209, 0xffff0000, v211
  ds_write_b32 v215, v208 offset:27008
  ds_write_b32 v215, v209 offset:29088
  v_lshlrev_b32 v208, 16, v174
  v_and_b32 v209, 0xffff0000, v174
  v_sub_f32 v208, v208, v210
  v_sub_f32 v209, v209, v210
  v_mul_f32 v208, s64, v208
  v_mul_f32 v209, s64, v209
  v_exp_f32 v208, v208
  v_exp_f32 v209, v209
  v_mul_f32 v208, v208, v213
  v_mul_f32 v209, v209, v213
  v_cvt_pk_bf16_f32 v211, v208, v209
  v_lshlrev_b32 v208, 16, v211
  v_and_b32 v209, 0xffff0000, v211
  ds_write_b32 v215, v208 offset:31168
  ds_write_b32 v215, v209 offset:33248
  v_and_b32 v216, 127, v218
  v_lshl_add_u32 v215, v216, 2, v220
  v_add_u32 v218, 16, v218
  v_lshlrev_b32 v208, 16, v176
  v_and_b32 v209, 0xffff0000, v176
  v_sub_f32 v208, v208, v210
  v_sub_f32 v209, v209, v210
  v_mul_f32 v208, s64, v208
  v_mul_f32 v209, s64, v209
  v_exp_f32 v208, v208
  v_exp_f32 v209, v209
  v_mul_f32 v208, v208, v213
  v_mul_f32 v209, v209, v213
  v_cvt_pk_bf16_f32 v211, v208, v209
  v_lshlrev_b32 v208, 16, v211
  v_and_b32 v209, 0xffff0000, v211
  ds_write_b32 v215, v208 offset:27008
  ds_write_b32 v215, v209 offset:29088
  v_lshlrev_b32 v208, 16, v178
  v_and_b32 v209, 0xffff0000, v178
  v_sub_f32 v208, v208, v210
  v_sub_f32 v209, v209, v210
  v_mul_f32 v208, s64, v208
  v_mul_f32 v209, s64, v209
  v_exp_f32 v208, v208
  v_exp_f32 v209, v209
  v_mul_f32 v208, v208, v213
  v_mul_f32 v209, v209, v213
  v_cvt_pk_bf16_f32 v211, v208, v209
  v_lshlrev_b32 v208, 16, v211
  v_and_b32 v209, 0xffff0000, v211
  ds_write_b32 v215, v208 offset:31168
  ds_write_b32 v215, v209 offset:33248
  v_and_b32 v216, 127, v218
  v_lshl_add_u32 v215, v216, 2, v220
  v_add_u32 v218, 16, v218
  v_lshlrev_b32 v208, 16, v180
  v_and_b32 v209, 0xffff0000, v180
  v_sub_f32 v208, v208, v210
  v_sub_f32 v209, v209, v210
  v_mul_f32 v208, s64, v208
  v_mul_f32 v209, s64, v209
  v_exp_f32 v208, v208
  v_exp_f32 v209, v209
  v_mul_f32 v208, v208, v213
  v_mul_f32 v209, v209, v213
  v_cvt_pk_bf16_f32 v211, v208, v209
  v_lshlrev_b32 v208, 16, v211
  v_and_b32 v209, 0xffff0000, v211
  ds_write_b32 v215, v208 offset:27008
  ds_write_b32 v215, v209 offset:29088
  v_lshlrev_b32 v208, 16, v182
  v_and_b32 v209, 0xffff0000, v182
  v_sub_f32 v208, v208, v210
  v_sub_f32 v209, v209, v210
  v_mul_f32 v208, s64, v208
  v_mul_f32 v209, s64, v209
  v_exp_f32 v208, v208
  v_exp_f32 v209, v209
  v_mul_f32 v208, v208, v213
  v_mul_f32 v209, v209, v213
  v_cvt_pk_bf16_f32 v211, v208, v209
  v_lshlrev_b32 v208, 16, v211
  v_and_b32 v209, 0xffff0000, v211
  ds_write_b32 v215, v208 offset:31168
  ds_write_b32 v215, v209 offset:33248
  v_and_b32 v216, 127, v218
  v_lshl_add_u32 v215, v216, 2, v220
  v_add_u32 v218, 16, v218
  v_lshlrev_b32 v208, 16, v184
  v_and_b32 v209, 0xffff0000, v184
  v_sub_f32 v208, v208, v210
  v_sub_f32 v209, v209, v210
  v_mul_f32 v208, s64, v208
  v_mul_f32 v209, s64, v209
  v_exp_f32 v208, v208
  v_exp_f32 v209, v209
  v_mul_f32 v208, v208, v213
  v_mul_f32 v209, v209, v213
  v_cvt_pk_bf16_f32 v211, v208, v209
  v_lshlrev_b32 v208, 16, v211
  v_and_b32 v209, 0xffff0000, v211
  ds_write_b32 v215, v208 offset:27008
  ds_write_b32 v215, v209 offset:29088
  v_lshlrev_b32 v208, 16, v186
  v_and_b32 v209, 0xffff0000, v186
  v_sub_f32 v208, v208, v210
  v_sub_f32 v209, v209, v210
  v_mul_f32 v208, s64, v208
  v_mul_f32 v209, s64, v209
  v_exp_f32 v208, v208
  v_exp_f32 v209, v209
  v_mul_f32 v208, v208, v213
  v_mul_f32 v209, v209, v213
  v_cvt_pk_bf16_f32 v211, v208, v209
  v_lshlrev_b32 v208, 16, v211
  v_and_b32 v209, 0xffff0000, v211
  ds_write_b32 v215, v208 offset:31168
  ds_write_b32 v215, v209 offset:33248
  v_and_b32 v216, 127, v218
  v_lshl_add_u32 v215, v216, 2, v220
  v_add_u32 v218, 16, v218
  v_lshlrev_b32 v208, 16, v188
  v_and_b32 v209, 0xffff0000, v188
  v_sub_f32 v208, v208, v210
  v_sub_f32 v209, v209, v210
  v_mul_f32 v208, s64, v208
  v_mul_f32 v209, s64, v209
  v_exp_f32 v208, v208
  v_exp_f32 v209, v209
  v_mul_f32 v208, v208, v213
  v_mul_f32 v209, v209, v213
  v_cvt_pk_bf16_f32 v211, v208, v209
  v_lshlrev_b32 v208, 16, v211
  v_and_b32 v209, 0xffff0000, v211
  ds_write_b32 v215, v208 offset:27008
  ds_write_b32 v215, v209 offset:29088
  v_lshlrev_b32 v208, 16, v190
  v_and_b32 v209, 0xffff0000, v190
  v_sub_f32 v208, v208, v210
  v_sub_f32 v209, v209, v210
  v_mul_f32 v208, s64, v208
  v_mul_f32 v209, s64, v209
  v_exp_f32 v208, v208
  v_exp_f32 v209, v209
  v_mul_f32 v208, v208, v213
  v_mul_f32 v209, v209, v213
  v_cvt_pk_bf16_f32 v211, v208, v209
  v_lshlrev_b32 v208, 16, v211
  v_and_b32 v209, 0xffff0000, v211
  ds_write_b32 v215, v208 offset:31168
  ds_write_b32 v215, v209 offset:33248
  v_and_b32 v216, 127, v218
  v_lshl_add_u32 v215, v216, 2, v220
  v_add_u32 v218, 16, v218
  v_lshlrev_b32 v208, 16, v192
  v_and_b32 v209, 0xffff0000, v192
  v_sub_f32 v208, v208, v210
  v_sub_f32 v209, v209, v210
  v_mul_f32 v208, s64, v208
  v_mul_f32 v209, s64, v209
  v_exp_f32 v208, v208
  v_exp_f32 v209, v209
  v_mul_f32 v208, v208, v213
  v_mul_f32 v209, v209, v213
  v_cvt_pk_bf16_f32 v211, v208, v209
  v_lshlrev_b32 v208, 16, v211
  v_and_b32 v209, 0xffff0000, v211
  ds_write_b32 v215, v208 offset:27008
  ds_write_b32 v215, v209 offset:29088
  v_lshlrev_b32 v208, 16, v194
  v_and_b32 v209, 0xffff0000, v194
  v_sub_f32 v208, v208, v210
  v_sub_f32 v209, v209, v210
  v_mul_f32 v208, s64, v208
  v_mul_f32 v209, s64, v209
  v_exp_f32 v208, v208
  v_exp_f32 v209, v209
  v_mul_f32 v208, v208, v213
  v_mul_f32 v209, v209, v213
  v_cvt_pk_bf16_f32 v211, v208, v209
  v_lshlrev_b32 v208, 16, v211
  v_and_b32 v209, 0xffff0000, v211
  ds_write_b32 v215, v208 offset:31168
  ds_write_b32 v215, v209 offset:33248
  v_and_b32 v216, 127, v218
  v_lshl_add_u32 v215, v216, 2, v220
  v_add_u32 v218, 16, v218
  v_lshlrev_b32 v208, 16, v196
  v_and_b32 v209, 0xffff0000, v196
  v_sub_f32 v208, v208, v210
  v_sub_f32 v209, v209, v210
  v_mul_f32 v208, s64, v208
  v_mul_f32 v209, s64, v209
  v_exp_f32 v208, v208
  v_exp_f32 v209, v209
  v_mul_f32 v208, v208, v213
  v_mul_f32 v209, v209, v213
  v_cvt_pk_bf16_f32 v211, v208, v209
  v_lshlrev_b32 v208, 16, v211
  v_and_b32 v209, 0xffff0000, v211
  ds_write_b32 v215, v208 offset:27008
  ds_write_b32 v215, v209 offset:29088
  v_lshlrev_b32 v208, 16, v198
  v_and_b32 v209, 0xffff0000, v198
  v_sub_f32 v208, v208, v210
  v_sub_f32 v209, v209, v210
  v_mul_f32 v208, s64, v208
  v_mul_f32 v209, s64, v209
  v_exp_f32 v208, v208
  v_exp_f32 v209, v209
  v_mul_f32 v208, v208, v213
  v_mul_f32 v209, v209, v213
  v_cvt_pk_bf16_f32 v211, v208, v209
  v_lshlrev_b32 v208, 16, v211
  v_and_b32 v209, 0xffff0000, v211
  ds_write_b32 v215, v208 offset:31168
  ds_write_b32 v215, v209 offset:33248
  v_and_b32 v216, 127, v218
  v_lshl_add_u32 v215, v216, 2, v220
  v_add_u32 v218, 16, v218
  v_lshlrev_b32 v208, 16, v200
  v_and_b32 v209, 0xffff0000, v200
  v_sub_f32 v208, v208, v210
  v_sub_f32 v209, v209, v210
  v_mul_f32 v208, s64, v208
  v_mul_f32 v209, s64, v209
  v_exp_f32 v208, v208
  v_exp_f32 v209, v209
  v_mul_f32 v208, v208, v213
  v_mul_f32 v209, v209, v213
  v_cvt_pk_bf16_f32 v211, v208, v209
  v_lshlrev_b32 v208, 16, v211
  v_and_b32 v209, 0xffff0000, v211
  ds_write_b32 v215, v208 offset:27008
  ds_write_b32 v215, v209 offset:29088
  v_lshlrev_b32 v208, 16, v202
  v_and_b32 v209, 0xffff0000, v202
  v_sub_f32 v208, v208, v210
  v_sub_f32 v209, v209, v210
  v_mul_f32 v208, s64, v208
  v_mul_f32 v209, s64, v209
  v_exp_f32 v208, v208
  v_exp_f32 v209, v209
  v_mul_f32 v208, v208, v213
  v_mul_f32 v209, v209, v213
  v_cvt_pk_bf16_f32 v211, v208, v209
  v_lshlrev_b32 v208, 16, v211
  v_and_b32 v209, 0xffff0000, v211
  ds_write_b32 v215, v208 offset:31168
  ds_write_b32 v215, v209 offset:33248
  v_and_b32 v216, 127, v218
  v_lshl_add_u32 v215, v216, 2, v220
  v_add_u32 v218, 16, v218
  v_lshlrev_b32 v208, 16, v204
  v_and_b32 v209, 0xffff0000, v204
  v_sub_f32 v208, v208, v210
  v_sub_f32 v209, v209, v210
  v_mul_f32 v208, s64, v208
  v_mul_f32 v209, s64, v209
  v_exp_f32 v208, v208
  v_exp_f32 v209, v209
  v_mul_f32 v208, v208, v213
  v_mul_f32 v209, v209, v213
  v_cvt_pk_bf16_f32 v211, v208, v209
  v_lshlrev_b32 v208, 16, v211
  v_and_b32 v209, 0xffff0000, v211
  ds_write_b32 v215, v208 offset:27008
  ds_write_b32 v215, v209 offset:29088
  v_lshlrev_b32 v208, 16, v206
  v_and_b32 v209, 0xffff0000, v206
  v_sub_f32 v208, v208, v210
  v_sub_f32 v209, v209, v210
  v_mul_f32 v208, s64, v208
  v_mul_f32 v209, s64, v209
  v_exp_f32 v208, v208
  v_exp_f32 v209, v209
  v_mul_f32 v208, v208, v213
  v_mul_f32 v209, v209, v213
  v_cvt_pk_bf16_f32 v211, v208, v209
  v_lshlrev_b32 v208, 16, v211
  v_and_b32 v209, 0xffff0000, v211
  ds_write_b32 v215, v208 offset:31168
  ds_write_b32 v215, v209 offset:33248
  s_waitcnt lgkmcnt(0)
  ds_add_u32 v86, v87 offset:12
L_nosm:
L_w_33:
  ds_read_b32 v50, v86 offset:12
  s_waitcnt lgkmcnt(0)
  v_readfirstlane_b32 s70, v50
  s_cmp_ge_u32 s70, 64
  s_cbranch_scc1 L_wd_34
  s_sleep 16
  s_branch L_w_33
L_wd_34:
  s_cmp_lg_u32 s68, 1
  s_cbranch_scc1 L_nocm
  s_mov_b32 s64, 9472
  s_mov_b32 s71, 262144
L_p_35:
  buffer_load_dwordx2 v[32:33], v13, s[44:47], s64 offen offset:0 sc1
  buffer_load_dwordx2 v[34:35], v13, s[44:47], s64 offen offset:256 sc1
  buffer_load_dwordx2 v[36:37], v13, s[44:47], s64 offen offset:512 sc1
  buffer_load_dwordx2 v[38:39], v13, s[44:47], s64 offen offset:768 sc1
  buffer_load_dwordx2 v[40:41], v13, s[44:47], s64 offen offset:1024 sc1
  buffer_load_dwordx2 v[42:43], v13, s[44:47], s64 offen offset:1280 sc1
  buffer_load_dwordx2 v[44:45], v13, s[44:47], s64 offen offset:1536 sc1
  buffer_load_dwordx2 v[46:47], v13, s[44:47], s64 offen offset:1792 sc1
  buffer_load_dwordx2 v[48:49], v13, s[44:47], s64 offen offset:2048 sc1
  buffer_load_dwordx2 v[50:51], v13, s[44:47], s64 offen offset:2304 sc1
  buffer_load_dwordx2 v[52:53], v13, s[44:47], s64 offen offset:2560 sc1
  buffer_load_dwordx2 v[54:55], v13, s[44:47], s64 offen offset:2816 sc1
  buffer_load_dwordx2 v[56:57], v13, s[44:47], s64 offen offset:3072 sc1
  buffer_load_dwordx2 v[58:59], v13, s[44:47], s64 offen offset:3328 sc1
  s_waitcnt vmcnt(0)
  v_xor_b32 v60, s33, v33
  v_xor_b32 v24, s33, v35
  v_or_b32 v60, v60, v24
  v_xor_b32 v24, s33, v37
  v_xor_b32 v25, s33, v39
  v_or3_b32 v60, v60, v24, v25
  v_xor_b32 v24, s33, v41
  v_xor_b32 v25, s33, v43
  v_or3_b32 v60, v60, v24, v25
  v_xor_b32 v24, s33, v45
  v_xor_b32 v25, s33, v47
  v_or3_b32 v60, v60, v24, v25
  v_xor_b32 v24, s33, v49
  v_xor_b32 v25, s33, v51
  v_or3_b32 v60, v60, v24, v25
  v_xor_b32 v24, s33, v53
  v_xor_b32 v25, s33, v55
  v_or3_b32 v60, v60, v24, v25
  v_xor_b32 v24, s33, v57
  v_xor_b32 v25, s33, v59
  v_or3_b32 v60, v60, v24, v25
  v_cmp_ne_u32 vcc, 0, v60
  s_cbranch_vccz L_pd_36
  s_sub_u32 s71, s71, 1
  s_cmp_eq_u32 s71, 0
  s_cbranch_scc1 L_pd_36
  s_sleep 1
  s_branch L_p_35
L_pd_36:
  v_lshlrev_b32 v24, 16, v46
  v_and_b32 v25, 0xffff0000, v46
  v_add_f32 v24, 1.0, v24
  v_add_f32 v25, 1.0, v25
  v_cvt_pk_bf16_f32 v26, v24, v25
  v_lshlrev_b32 v116, 16, v26
  v_and_b32 v117, 0xffff0000, v26
  v_lshlrev_b32 v130, 16, v32
  v_and_b32 v131, 0xffff0000, v32
  v_lshlrev_b32 v24, 16, v48
  v_and_b32 v25, 0xffff0000, v48
  v_add_f32 v24, 1.0, v24
  v_add_f32 v25, 1.0, v25
  v_cvt_pk_bf16_f32 v26, v24, v25
  v_lshlrev_b32 v118, 16, v26
  v_and_b32 v119, 0xffff0000, v26
  v_lshlrev_b32 v132, 16, v34
  v_and_b32 v133, 0xffff0000, v34
  v_lshlrev_b32 v24, 16, v50
  v_and_b32 v25, 0xffff0000, v50
  v_add_f32 v24, 1.0, v24
  v_add_f32 v25, 1.0, v25
  v_cvt_pk_bf16_f32 v26, v24, v25
  v_lshlrev_b32 v120, 16, v26
  v_and_b32 v121, 0xffff0000, v26
  v_lshlrev_b32 v134, 16, v36
  v_and_b32 v135, 0xffff0000, v36
  v_lshlrev_b32 v24, 16, v52
  v_and_b32 v25, 0xffff0000, v52
  v_add_f32 v24, 1.0, v24
  v_add_f32 v25, 1.0, v25
  v_cvt_pk_bf16_f32 v26, v24, v25
  v_lshlrev_b32 v122, 16, v26
  v_and_b32 v123, 0xffff0000, v26
  v_lshlrev_b32 v136, 16, v38
  v_and_b32 v137, 0xffff0000, v38
  v_lshlrev_b32 v24, 16, v54
  v_and_b32 v25, 0xffff0000, v54
  v_add_f32 v24, 1.0, v24
  v_add_f32 v25, 1.0, v25
  v_cvt_pk_bf16_f32 v26, v24, v25
  v_lshlrev_b32 v124, 16, v26
  v_and_b32 v125, 0xffff0000, v26
  v_lshlrev_b32 v138, 16, v40
  v_and_b32 v139, 0xffff0000, v40
  v_lshlrev_b32 v24, 16, v56
  v_and_b32 v25, 0xffff0000, v56
  v_add_f32 v24, 1.0, v24
  v_add_f32 v25, 1.0, v25
  v_cvt_pk_bf16_f32 v26, v24, v25
  v_lshlrev_b32 v126, 16, v26
  v_and_b32 v127, 0xffff0000, v26
  v_lshlrev_b32 v140, 16, v42
  v_and_b32 v141, 0xffff0000, v42
  v_lshlrev_b32 v24, 16, v58
  v_and_b32 v25, 0xffff0000, v58
  v_add_f32 v24, 1.0, v24
  v_add_f32 v25, 1.0, v25
  v_cvt_pk_bf16_f32 v26, v24, v25
  v_lshlrev_b32 v128, 16, v26
  v_and_b32 v129, 0xffff0000, v26
  v_lshlrev_b32 v142, 16, v44
  v_and_b32 v143, 0xffff0000, v44
L_nocm:
L_w_37:
  ds_read_b32 v50, v86 offset:40
  s_waitcnt lgkmcnt(0)
  v_readfirstlane_b32 s70, v50
  s_cmp_ge_u32 s70, 64
  s_cbranch_scc1 L_wd_38
  s_sleep 8
  s_branch L_w_37
L_wd_38:
  s_sub_u32 s64, s40, 2
  s_cmp_ge_u32 s64, 2
  s_cbranch_scc1 L_cp_39
  s_mul_i32 s64, s64, 1024
  s_lshl_b32 s65, s35, 11
  s_add_u32 s64, s64, s65
  v_lshlrev_b32 v224, 4, v0
  v_add_u32 v224, s64, v224
  v_cmp_gt_u32 vcc, CODE_BYTES, v224
  s_and_saveexec_b64 s[74:75], vcc
  s_cbranch_execz L_cp_39_r
  global_load_dwordx4 v[228:231], v224, s[76:77]
L_cp_39_r:
  s_mov_b64 exec, s[74:75]
L_cp_39:
  s_cmp_lt_u32 s68, 3
  s_cbranch_scc1 L_nowt
  s_mov_b32 s56, s12
  s_mov_b32 s57, s13
  s_mov_b32 s58, 3670016
  s_mov_b32 s59, 0x20000
  v_lshrrev_b32 v24, 3, v0
  v_mul_u32_u24 v24, 896, v24
  v_and_b32 v25, 7, v0
  v_lshlrev_b32 v25, 4, v25
  v_add_u32 v24, v24, v25
  s_lshl_b32 s64, s36, 8
  s_lshl_b32 s65, s40, 6
  s_add_u32 s64, s64, s65
  s_mul_i32 s64, s64, 896
  s_lshl_b32 s65, s42, 7
  s_add_u32 s66, s64, s65
  s_lshl_b32 s65, s40, 13
  s_add_u32 s65, s65, 43776
  s_add_u32 m0, s65, 0
  s_nop 0
  buffer_load_dwordx4 v24, s[56:59], s66 offen nt lds
  s_add_u32 s66, s66, 7168
  s_add_u32 m0, s65, 1024
  s_nop 0
  buffer_load_dwordx4 v24, s[56:59], s66 offen nt lds
  s_add_u32 s66, s66, 7168
  s_add_u32 m0, s65, 2048
  s_nop 0
  buffer_load_dwordx4 v24, s[56:59], s66 offen nt lds
  s_add_u32 s66, s66, 7168
  s_add_u32 m0, s65, 3072
  s_nop 0
  buffer_load_dwordx4 v24, s[56:59], s66 offen nt lds
  s_add_u32 s66, s66, 7168
  s_add_u32 m0, s65, 4096
  s_nop 0
  buffer_load_dwordx4 v24, s[56:59], s66 offen nt lds
  s_add_u32 s66, s66, 7168
  s_add_u32 m0, s65, 5120
  s_nop 0
  buffer_load_dwordx4 v24, s[56:59], s66 offen nt lds
  s_add_u32 s66, s66, 7168
  s_add_u32 m0, s65, 6144
  s_nop 0
  buffer_load_dwordx4 v24, s[56:59], s66 offen nt lds
  s_add_u32 s66, s66, 7168
  s_add_u32 m0, s65, 7168
  s_nop 0
  buffer_load_dwordx4 v24, s[56:59], s66 offen nt lds
  s_add_u32 s66, s66, 7168
L_nowt:
  s_waitcnt vmcnt(0)
  s_cmp_lt_u32 s68, 3
  s_cbranch_scc1 L_nowt2
  s_waitcnt lgkmcnt(0)
  ds_add_u32 v86, v87 offset:36
L_w_40:
  ds_read_b32 v50, v86 offset:36
  s_waitcnt lgkmcnt(0)
  v_readfirstlane_b32 s70, v50
  s_cmp_ge_u32 s70, 256
  s_cbranch_scc1 L_wd_41
  s_branch L_w_40
L_wd_41:
  v_lshlrev_b32 v24, 3, v3
  v_lshrrev_b32 v25, 2, v4
  v_add_u32 v24, v24, v25
  v_lshlrev_b32 v24, 7, v24
  v_and_b32 v25, 3, v4
  v_lshlrev_b32 v25, 3, v25
  v_add_u32 v24, v24, v25
  s_lshl_b32 s64, s40, 5
  s_add_u32 s64, s64, 43776
  v_add_u32 v24, s64, v24
  ds_read_b64_tr_b16 v[144:145], v24 offset:0
  ds_read_b64_tr_b16 v[146:147], v24 offset:512
  ds_read_b64_tr_b16 v[148:149], v24 offset:4096
  ds_read_b64_tr_b16 v[150:151], v24 offset:4608
  ds_read_b64_tr_b16 v[152:153], v24 offset:8192
  ds_read_b64_tr_b16 v[154:155], v24 offset:8704
  ds_read_b64_tr_b16 v[156:157], v24 offset:12288
  ds_read_b64_tr_b16 v[158:159], v24 offset:12800
  ds_read_b64_tr_b16 v[160:161], v24 offset:16384
  ds_read_b64_tr_b16 v[162:163], v24 offset:16896
  ds_read_b64_tr_b16 v[164:165], v24 offset:20480
  ds_read_b64_tr_b16 v[166:167], v24 offset:20992
  ds_read_b64_tr_b16 v[168:169], v24 offset:24576
  ds_read_b64_tr_b16 v[170:171], v24 offset:25088
  ds_read_b64_tr_b16 v[172:173], v24 offset:28672
  ds_read_b64_tr_b16 v[174:175], v24 offset:29184
L_nowt2:
  s_cmp_lt_u32 s68, 3
  s_cbranch_scc1 L_ydone
  v_lshrrev_b32 v24, 3, v4
  v_lshlrev_b32 v24, 9, v24
  v_lshlrev_b32 v25, 7, v3
  v_and_b32 v26, 7, v0
  v_lshlrev_b32 v26, 4, v26
  v_add_u32 v25, v25, v26
  v_add_u32 v24, v24, v25
  s_lshl_b32 s64, s40, 10
  v_add_u32 v24, s64, v24
  s_lshl_b32 s64, s36, 12
  s_add_u32 s64, s64, 327680
  s_mov_b32 s71, 262144
L_p_42:
  buffer_load_dwordx4 v[208:211], v24, s[44:47], s64 offen sc1
  s_waitcnt vmcnt(0)
  v_max3_u32 v60, v208, v209, v210
  v_max_u32 v60, v60, v211
  v_cmp_eq_u32 vcc, -1, v60
  s_cbranch_vccz L_pd_43
  s_sub_u32 s71, s71, 1
  s_cmp_eq_u32 s71, 0
  s_cbranch_scc1 L_pd_43
  s_branch L_p_42
L_pd_43:
  ds_write_b128 v24, v[208:211] offset:7552
  s_waitcnt lgkmcnt(0)
  s_barrier
  ds_read_b128 v[176:179], v25 offset:7552
  ds_read_b128 v[180:183], v25 offset:8064
  ds_read_b128 v[184:187], v25 offset:8576
  ds_read_b128 v[188:191], v25 offset:9088
  ds_read_b128 v[192:195], v25 offset:9600
  ds_read_b128 v[196:199], v25 offset:10112
  ds_read_b128 v[200:203], v25 offset:10624
  ds_read_b128 v[204:207], v25 offset:11136
  s_waitcnt lgkmcnt(0)
  v_mfma_f32_16x16x32_bf16 v[32:35], v[144:147], v[176:179], 0
  v_mfma_f32_16x16x32_bf16 v[32:35], v[148:151], v[180:183], v[32:35]
  v_mfma_f32_16x16x32_bf16 v[32:35], v[152:155], v[184:187], v[32:35]
  v_mfma_f32_16x16x32_bf16 v[32:35], v[156:159], v[188:191], v[32:35]
  v_mfma_f32_16x16x32_bf16 v[32:35], v[160:163], v[192:195], v[32:35]
  v_mfma_f32_16x16x32_bf16 v[32:35], v[164:167], v[196:199], v[32:35]
  v_mfma_f32_16x16x32_bf16 v[32:35], v[168:171], v[200:203], v[32:35]
  v_mfma_f32_16x16x32_bf16 v[32:35], v[172:175], v[204:207], v[32:35]
  s_nop 7
  v_min_u32 v32, 0xfffffffe, v32
  v_min_u32 v33, 0xfffffffe, v33
  v_min_u32 v34, 0xfffffffe, v34
  v_min_u32 v35, 0xfffffffe, v35
  s_lshl_b32 s64, s40, 6
  s_add_u32 s64, s64, s72
  s_mov_b32 exec_lo, 0x00ff00ff
  s_mov_b32 exec_hi, 0x00ff00ff
  buffer_store_dwordx4 v[32:35], v65, s[44:47], s64 offen sc1
  s_mov_b64 exec, -1
L_ydone:
  s_cmp_eq_u32 s68, 1
  s_cbranch_scc1 L_UP
  s_cmp_eq_u32 s68, 2
  s_cbranch_scc1 L_DOWN
  s_cmp_eq_u32 s68, 3
  s_cbranch_scc1 L_RED
  s_branch L_FIN
L_RED:
  s_mul_i32 s64, s34, 28672
  s_lshl_b32 s65, s69, 12
  s_add_u32 s65, s65, s64
  s_lshl_b32 s64, s40, 10
  s_add_u32 s65, s65, s64
  s_add_u32 s65, s65, 393216
  s_mov_b32 s71, 262144
L_p_44:
  buffer_load_dwordx4 v[216:219], v9, s[44:47], s65 offen sc1
  s_waitcnt vmcnt(0)
  v_max3_u32 v60, v216, v217, v218
  v_max_u32 v60, v60, v219
  v_cmp_eq_u32 vcc, -1, v60
  s_cbranch_vccz L_pd_45
  s_sub_u32 s71, s71, 1
  s_cmp_eq_u32 s71, 0
  s_cbranch_scc1 L_pd_45
  s_branch L_p_44
L_pd_45:
  v_mov_b32 v144, v216
  v_mov_b32 v145, v217
  v_mov_b32 v146, v218
  v_mov_b32 v147, v219
  v_permlane32_swap_b32 v144, v145
  s_nop 0
  v_permlane32_swap_b32 v146, v147
  v_add_f32 v144, v144, v145
  v_add_f32 v146, v146, v147
  s_nop 1
  v_permlane16_swap_b32 v144, v146
  v_add_f32 v144, v144, v146
  s_lshl_b32 s64, s40, 8
  v_lshlrev_b32 v24, 2, v0
  v_add_u32 v25, s64, v24
  ds_write_b32 v25, v144 offset:11648
  s_waitcnt lgkmcnt(0)
  s_barrier
  s_cmp_lg_u32 s40, 0
  s_cbranch_scc1 L_FIN
  ds_read_b32 v32, v24 offset:11648
  ds_read_b32 v33, v24 offset:11904
  ds_read_b32 v34, v24 offset:12160
  ds_read_b32 v35, v24 offset:12416
  s_waitcnt lgkmcnt(0)
  v_add_f32 v32, v32, v33
  v_add_f32 v34, v34, v35
  v_add_f32 v32, v32, v34
  v_cvt_pk_bf16_f32 v32, v32, v32
  v_lshlrev_b32 v32, 16, v32
  v_mul_f32 v32, v32, v69
  v_cvt_pk_bf16_f32 v32, v32, v32
  v_lshlrev_b32 v32, 16, v32
  v_add_f32 v32, v32, v68
  v_mov_b32 v33, v32
  s_nop 1
  v_permlane32_swap_b32 v32, v33
  v_cvt_pk_bf16_f32 v36, v32, v33
  v_min_u32 v36, 0xfffffffe, v36
  v_lshlrev_b32 v24, 3, v4
  v_and_b32 v25, 1, v3
  v_lshlrev_b32 v25, 2, v25
  v_add_u32 v24, v24, v25
  s_mul_i32 s64, s34, 896
  s_lshl_b32 s65, s69, 7
  s_add_u32 s64, s64, s65
  s_add_u32 s64, s64, 655360
  v_lshlrev_b32 v25, 13, v2
  v_add_u32 v24, v24, v25
  s_mov_b32 exec_hi, 0
  buffer_store_dword v36, v24, s[44:47], s64 offen sc1
  s_mov_b64 exec, -1
  s_branch L_FIN
L_UP:
L_w_46:
  ds_read_b32 v50, v86 offset:48
  s_waitcnt lgkmcnt(0)
  v_readfirstlane_b32 s70, v50
  s_cmp_ge_u32 s70, 64
  s_cbranch_scc1 L_wd_47
  s_sleep 2
  s_branch L_w_46
L_wd_47:
L_w_48:
  ds_read_b32 v50, v86 offset:44
  s_waitcnt lgkmcnt(0)
  v_readfirstlane_b32 s70, v50
  s_cmp_ge_u32 s70, 256
  s_cbranch_scc1 L_wd_49
  s_branch L_w_48
L_wd_49:
  ds_read_b64_tr_b16 v[88:89], v5 offset:0
  ds_read_b64_tr_b16 v[90:91], v5 offset:128
  ds_read_b64_tr_b16 v[92:93], v5 offset:1024
  ds_read_b64_tr_b16 v[94:95], v5 offset:1152
  ds_read_b64_tr_b16 v[96:97], v5 offset:2048
  ds_read_b64_tr_b16 v[98:99], v5 offset:2176
  ds_read_b64_tr_b16 v[100:101], v5 offset:3072
  ds_read_b64_tr_b16 v[102:103], v5 offset:3200
  ds_read_b64_tr_b16 v[104:105], v5 offset:4096
  ds_read_b64_tr_b16 v[106:107], v5 offset:4224
  ds_read_b64_tr_b16 v[108:109], v5 offset:5120
  ds_read_b64_tr_b16 v[110:111], v5 offset:5248
  ds_read_b64_tr_b16 v[112:113], v5 offset:6144
  ds_read_b64_tr_b16 v[114:115], v5 offset:6272
  s_lshl_b32 s64, s40, 1
  v_add_u32 v10, s64, v2
  v_mul_u32_u24 v24, 896, v10
  v_lshlrev_b32 v25, 2, v1
  v_add_u32 v24, v24, v25
  s_and_b32 s64, s34, 0
  s_lshl_b32 s64, s64, 13
  s_add_u32 s64, s64, 655360
  s_mov_b32 s71, 262144
L_p_50:
  buffer_load_dword v208, v24, s[44:47], s64 offen offset:0 sc1
  buffer_load_dword v209, v24, s[44:47], s64 offen offset:128 sc1
  buffer_load_dword v210, v24, s[44:47], s64 offen offset:256 sc1
  buffer_load_dword v211, v24, s[44:47], s64 offen offset:384 sc1
  buffer_load_dword v212, v24, s[44:47], s64 offen offset:512 sc1
  buffer_load_dword v213, v24, s[44:47], s64 offen offset:640 sc1
  buffer_load_dword v214, v24, s[44:47], s64 offen offset:768 sc1
  s_waitcnt vmcnt(0)
  v_max3_u32 v60, v208, v209, v210
  v_max3_u32 v60, v60, v211, v212
  v_max3_u32 v60, v60, v213, v214
  v_cmp_eq_u32 vcc, -1, v60
  s_cbranch_vccz L_pd_51
  s_sub_u32 s71, s71, 1
  s_cmp_eq_u32 s71, 0
  s_cbranch_scc1 L_pd_51
  s_branch L_p_50
L_pd_51:
  v_lshlrev_b32 v32, 16, v208
  v_and_b32 v33, 0xffff0000, v208
  v_lshlrev_b32 v34, 16, v209
  v_and_b32 v35, 0xffff0000, v209
  v_lshlrev_b32 v36, 16, v210
  v_and_b32 v37, 0xffff0000, v210
  v_lshlrev_b32 v38, 16, v211
  v_and_b32 v39, 0xffff0000, v211
  v_lshlrev_b32 v40, 16, v212
  v_and_b32 v41, 0xffff0000, v212
  v_lshlrev_b32 v42, 16, v213
  v_and_b32 v43, 0xffff0000, v213
  v_lshlrev_b32 v44, 16, v214
  v_and_b32 v45, 0xffff0000, v214
  v_pk_add_f32 v[46:47], v[32:33], v[34:35]
  v_pk_add_f32 v[46:47], v[46:47], v[36:37]
  v_pk_add_f32 v[46:47], v[46:47], v[38:39]
  v_pk_add_f32 v[46:47], v[46:47], v[40:41]
  v_pk_add_f32 v[46:47], v[46:47], v[42:43]
  v_pk_add_f32 v[46:47], v[46:47], v[44:45]
  v_add_f32 v46, v46, v47
  s_nop 1
  v_add_f32_dpp v46, v46, v46 quad_perm:[1,0,3,2] row_mask:0xf bank_mask:0xf
  s_nop 1
  v_add_f32_dpp v46, v46, v46 quad_perm:[2,3,0,1] row_mask:0xf bank_mask:0xf
  s_nop 1
  v_add_f32_dpp v46, v46, v46 row_half_mirror row_mask:0xf bank_mask:0xf
  s_nop 1
  v_add_f32_dpp v46, v46, v46 row_mirror row_mask:0xf bank_mask:0xf
  v_mov_b32 v48, v46
  s_nop 1
  v_permlane16_swap_b32 v46, v48
  v_add_f32 v46, v46, v48
  v_mul_f32 v50, 0xbb124925, v46
  v_mul_f32 v51, 0xbb124925, v46
  v_pk_add_f32 v[48:49], v[32:33], v[50:51]
  v_pk_mul_f32 v[46:47], v[48:49], v[48:49]
  v_pk_add_f32 v[48:49], v[34:35], v[50:51]
  v_pk_fma_f32 v[46:47], v[48:49], v[48:49], v[46:47]
  v_pk_add_f32 v[48:49], v[36:37], v[50:51]
  v_pk_fma_f32 v[46:47], v[48:49], v[48:49], v[46:47]
  v_pk_add_f32 v[48:49], v[38:39], v[50:51]
  v_pk_fma_f32 v[46:47], v[48:49], v[48:49], v[46:47]
  v_pk_add_f32 v[48:49], v[40:41], v[50:51]
  v_pk_fma_f32 v[46:47], v[48:49], v[48:49], v[46:47]
  v_pk_add_f32 v[48:49], v[42:43], v[50:51]
  v_pk_fma_f32 v[46:47], v[48:49], v[48:49], v[46:47]
  v_pk_add_f32 v[48:49], v[44:45], v[50:51]
  v_pk_fma_f32 v[46:47], v[48:49], v[48:49], v[46:47]
  v_add_f32 v46, v46, v47
  s_nop 1
  v_add_f32_dpp v46, v46, v46 quad_perm:[1,0,3,2] row_mask:0xf bank_mask:0xf
  s_nop 1
  v_add_f32_dpp v46, v46, v46 quad_perm:[2,3,0,1] row_mask:0xf bank_mask:0xf
  s_nop 1
  v_add_f32_dpp v46, v46, v46 row_half_mirror row_mask:0xf bank_mask:0xf
  s_nop 1
  v_add_f32_dpp v46, v46, v46 row_mirror row_mask:0xf bank_mask:0xf
  v_mov_b32 v48, v46
  s_nop 1
  v_permlane16_swap_b32 v46, v48
  v_add_f32 v46, v46, v48
  v_mul_f32 v46, 0x3b124925, v46
  v_cvt_pk_bf16_f32 v48, v50, v46
  v_lshlrev_b32 v50, 16, v48
  v_lshlrev_b32 v51, 16, v48
  v_and_b32 v46, 0xffff0000, v48
  v_add_f32 v46, 0x3727c5ac, v46
  v_cvt_pk_bf16_f32 v46, v46, v46
  v_lshlrev_b32 v46, 16, v46
  v_sqrt_f32 v46, v46
  s_nop 0
  v_cvt_pk_bf16_f32 v46, v46, v46
  v_lshlrev_b32 v46, 16, v46
  v_rcp_f32 v52, v46
  v_rcp_f32 v53, v46
  v_pk_add_f32 v[32:33], v[32:33], v[50:51]
  v_pk_add_f32 v[34:35], v[34:35], v[50:51]
  v_pk_add_f32 v[36:37], v[36:37], v[50:51]
  v_pk_add_f32 v[38:39], v[38:39], v[50:51]
  v_pk_add_f32 v[40:41], v[40:41], v[50:51]
  v_pk_add_f32 v[42:43], v[42:43], v[50:51]
  v_pk_add_f32 v[44:45], v[44:45], v[50:51]
  v_cvt_pk_bf16_f32 v54, v32, v33
  v_lshlrev_b32 v32, 16, v54
  v_and_b32 v33, 0xffff0000, v54
  v_pk_mul_f32 v[32:33], v[32:33], v[52:53]
  v_cvt_pk_bf16_f32 v54, v32, v33
  v_lshlrev_b32 v32, 16, v54
  v_and_b32 v33, 0xffff0000, v54
  v_pk_mul_f32 v[32:33], v[32:33], v[116:117]
  v_cvt_pk_bf16_f32 v54, v32, v33
  v_lshlrev_b32 v32, 16, v54
  v_and_b32 v33, 0xffff0000, v54
  v_pk_add_f32 v[32:33], v[32:33], v[130:131]
  v_cvt_pk_bf16_f32 v54, v32, v33
  ds_write_b32 v8, v54 offset:256
  v_cvt_pk_bf16_f32 v55, v34, v35
  v_lshlrev_b32 v34, 16, v55
  v_and_b32 v35, 0xffff0000, v55
  v_pk_mul_f32 v[34:35], v[34:35], v[52:53]
  v_cvt_pk_bf16_f32 v55, v34, v35
  v_lshlrev_b32 v34, 16, v55
  v_and_b32 v35, 0xffff0000, v55
  v_pk_mul_f32 v[34:35], v[34:35], v[118:119]
  v_cvt_pk_bf16_f32 v55, v34, v35
  v_lshlrev_b32 v34, 16, v55
  v_and_b32 v35, 0xffff0000, v55
  v_pk_add_f32 v[34:35], v[34:35], v[132:133]
  v_cvt_pk_bf16_f32 v55, v34, v35
  ds_write_b32 v8, v55 offset:384
  v_cvt_pk_bf16_f32 v54, v36, v37
  v_lshlrev_b32 v36, 16, v54
  v_and_b32 v37, 0xffff0000, v54
  v_pk_mul_f32 v[36:37], v[36:37], v[52:53]
  v_cvt_pk_bf16_f32 v54, v36, v37
  v_lshlrev_b32 v36, 16, v54
  v_and_b32 v37, 0xffff0000, v54
  v_pk_mul_f32 v[36:37], v[36:37], v[120:121]
  v_cvt_pk_bf16_f32 v54, v36, v37
  v_lshlrev_b32 v36, 16, v54
  v_and_b32 v37, 0xffff0000, v54
  v_pk_add_f32 v[36:37], v[36:37], v[134:135]
  v_cvt_pk_bf16_f32 v54, v36, v37
  ds_write_b32 v8, v54 offset:512
  v_cvt_pk_bf16_f32 v55, v38, v39
  v_lshlrev_b32 v38, 16, v55
  v_and_b32 v39, 0xffff0000, v55
  v_pk_mul_f32 v[38:39], v[38:39], v[52:53]
  v_cvt_pk_bf16_f32 v55, v38, v39
  v_lshlrev_b32 v38, 16, v55
  v_and_b32 v39, 0xffff0000, v55
  v_pk_mul_f32 v[38:39], v[38:39], v[122:123]
  v_cvt_pk_bf16_f32 v55, v38, v39
  v_lshlrev_b32 v38, 16, v55
  v_and_b32 v39, 0xffff0000, v55
  v_pk_add_f32 v[38:39], v[38:39], v[136:137]
  v_cvt_pk_bf16_f32 v55, v38, v39
  ds_write_b32 v8, v55 offset:640
  v_cvt_pk_bf16_f32 v54, v40, v41
  v_lshlrev_b32 v40, 16, v54
  v_and_b32 v41, 0xffff0000, v54
  v_pk_mul_f32 v[40:41], v[40:41], v[52:53]
  v_cvt_pk_bf16_f32 v54, v40, v41
  v_lshlrev_b32 v40, 16, v54
  v_and_b32 v41, 0xffff0000, v54
  v_pk_mul_f32 v[40:41], v[40:41], v[124:125]
  v_cvt_pk_bf16_f32 v54, v40, v41
  v_lshlrev_b32 v40, 16, v54
  v_and_b32 v41, 0xffff0000, v54
  v_pk_add_f32 v[40:41], v[40:41], v[138:139]
  v_cvt_pk_bf16_f32 v54, v40, v41
  ds_write_b32 v8, v54 offset:768
  v_cvt_pk_bf16_f32 v55, v42, v43
  v_lshlrev_b32 v42, 16, v55
  v_and_b32 v43, 0xffff0000, v55
  v_pk_mul_f32 v[42:43], v[42:43], v[52:53]
  v_cvt_pk_bf16_f32 v55, v42, v43
  v_lshlrev_b32 v42, 16, v55
  v_and_b32 v43, 0xffff0000, v55
  v_pk_mul_f32 v[42:43], v[42:43], v[126:127]
  v_cvt_pk_bf16_f32 v55, v42, v43
  v_lshlrev_b32 v42, 16, v55
  v_and_b32 v43, 0xffff0000, v55
  v_pk_add_f32 v[42:43], v[42:43], v[140:141]
  v_cvt_pk_bf16_f32 v55, v42, v43
  ds_write_b32 v8, v55 offset:896
  v_cvt_pk_bf16_f32 v54, v44, v45
  v_lshlrev_b32 v44, 16, v54
  v_and_b32 v45, 0xffff0000, v54
  v_pk_mul_f32 v[44:45], v[44:45], v[52:53]
  v_cvt_pk_bf16_f32 v54, v44, v45
  v_lshlrev_b32 v44, 16, v54
  v_and_b32 v45, 0xffff0000, v54
  v_pk_mul_f32 v[44:45], v[44:45], v[128:129]
  v_cvt_pk_bf16_f32 v54, v44, v45
  v_lshlrev_b32 v44, 16, v54
  v_and_b32 v45, 0xffff0000, v54
  v_pk_add_f32 v[44:45], v[44:45], v[142:143]
  v_cvt_pk_bf16_f32 v54, v44, v45
  ds_write_b32 v8, v54 offset:1024
  s_waitcnt lgkmcnt(0)
  s_barrier
  s_and_b32 s64, s40, 1
  s_mul_i32 s64, s64, 448
  v_add_u32 v50, s64, v7
  ds_read_b128 v[144:147], v50 offset:256
  ds_read_b128 v[148:151], v50 offset:320
  ds_read_b128 v[152:155], v50 offset:384
  ds_read_b128 v[156:159], v50 offset:448
  ds_read_b128 v[160:163], v50 offset:512
  ds_read_b128 v[164:167], v50 offset:576
  ds_read_b128 v[168:171], v50 offset:640
  s_waitcnt lgkmcnt(0)
  v_mfma_f32_16x16x32_bf16 v[32:35], v[88:91], v[144:147], 0
  v_mfma_f32_16x16x32_bf16 v[32:35], v[92:95], v[148:151], v[32:35]
  v_mfma_f32_16x16x32_bf16 v[32:35], v[96:99], v[152:155], v[32:35]
  v_mfma_f32_16x16x32_bf16 v[32:35], v[100:103], v[156:159], v[32:35]
  v_mfma_f32_16x16x32_bf16 v[32:35], v[104:107], v[160:163], v[32:35]
  v_mfma_f32_16x16x32_bf16 v[32:35], v[108:111], v[164:167], v[32:35]
  v_mfma_f32_16x16x32_bf16 v[32:35], v[112:115], v[168:171], v[32:35]
  s_lshl_b32 s64, s40, 10
  v_add_u32 v50, s64, v9
  s_nop 5
  ds_write_b128 v50, v[32:35] offset:7552
  s_waitcnt lgkmcnt(0)
  s_barrier
  s_cmp_lg_u32 s40, 0
  s_cbranch_scc1 L_FIN
  ds_read_b128 v[32:35], v9 offset:7552
  ds_read_b128 v[36:39], v9 offset:8576
  ds_read_b128 v[40:43], v9 offset:9600
  ds_read_b128 v[44:47], v9 offset:10624
  s_waitcnt lgkmcnt(0)
  v_add_f32 v48, v32, v36
  v_add_f32 v56, v40, v44
  v_add_f32 v49, v33, v37
  v_add_f32 v57, v41, v45
  v_add_f32 v50, v34, v38
  v_add_f32 v58, v42, v46
  v_add_f32 v51, v35, v39
  v_add_f32 v59, v43, v47
  v_cvt_pk_bf16_f32 v32, v48, v49
  v_cvt_pk_bf16_f32 v33, v50, v51
  v_cvt_pk_bf16_f32 v34, v56, v57
  v_cvt_pk_bf16_f32 v35, v58, v59
  v_lshlrev_b32 v48, 16, v32
  v_and_b32 v49, 0xffff0000, v32
  v_lshlrev_b32 v50, 16, v33
  v_and_b32 v51, 0xffff0000, v33
  v_lshlrev_b32 v56, 16, v34
  v_and_b32 v57, 0xffff0000, v34
  v_lshlrev_b32 v58, 16, v35
  v_and_b32 v59, 0xffff0000, v35
  s_mov_b32 s64, 0x3d122279
  v_mul_f32 v36, v48, v48
  v_mov_b32 v40, 0x3f4c422a
  v_mul_f32 v37, v49, v49
  v_mov_b32 v41, 0x3f4c422a
  v_mul_f32 v38, v50, v50
  v_mov_b32 v42, 0x3f4c422a
  v_mul_f32 v39, v51, v51
  v_mov_b32 v43, 0x3f4c422a
  v_fmac_f32 v40, s64, v36
  v_fmac_f32 v41, s64, v37
  v_fmac_f32 v42, s64, v38
  v_fmac_f32 v43, s64, v39
  v_mul_f32 v40, v40, v48
  v_mul_f32 v41, v41, v49
  v_mul_f32 v42, v42, v50
  v_mul_f32 v43, v43, v51
  v_mul_f32 v40, 0xc038aa3b, v40
  v_mul_f32 v41, 0xc038aa3b, v41
  v_mul_f32 v42, 0xc038aa3b, v42
  v_mul_f32 v43, 0xc038aa3b, v43
  v_exp_f32 v40, v40
  v_exp_f32 v41, v41
  v_exp_f32 v42, v42
  v_exp_f32 v43, v43
  v_add_f32 v40, 1.0, v40
  v_add_f32 v41, 1.0, v41
  v_add_f32 v42, 1.0, v42
  v_add_f32 v43, 1.0, v43
  v_rcp_f32 v40, v40
  v_rcp_f32 v41, v41
  v_rcp_f32 v42, v42
  v_rcp_f32 v43, v43
  v_mul_f32 v48, v48, v40
  v_mul_f32 v49, v49, v41
  v_mul_f32 v50, v50, v42
  v_mul_f32 v51, v51, v43
  v_cvt_pk_bf16_f32 v32, v48, v49
  v_cvt_pk_bf16_f32 v33, v50, v51
  v_lshlrev_b32 v48, 16, v32
  v_and_b32 v49, 0xffff0000, v32
  v_lshlrev_b32 v50, 16, v33
  v_and_b32 v51, 0xffff0000, v33
  v_mul_f32 v48, v48, v56
  v_mul_f32 v49, v49, v57
  v_mul_f32 v50, v50, v58
  v_mul_f32 v51, v51, v59
  v_cvt_pk_bf16_f32 v52, v48, v49
  v_cvt_pk_bf16_f32 v53, v50, v51
  v_min_u32 v52, 0xfffffffe, v52
  v_min_u32 v53, 0xfffffffe, v53
  s_lshl_b32 s64, s69, 8
  s_add_u32 s64, s64, 294912
  s_mov_b32 exec_lo, 0x00ff00ff
  s_mov_b32 exec_hi, 0x00ff00ff
  buffer_store_dwordx2 v[52:53], v66, s[44:47], s64 offen sc1
  s_mov_b64 exec, -1
  s_branch L_FIN
L_DOWN:
L_w_52:
  ds_read_b32 v50, v86 offset:44
  s_waitcnt lgkmcnt(0)
  v_readfirstlane_b32 s70, v50
  s_cmp_ge_u32 s70, 256
  s_cbranch_scc1 L_wd_53
  s_branch L_w_52
L_wd_53:
  ds_read_b64_tr_b16 v[88:89], v5 offset:0
  ds_read_b64_tr_b16 v[90:91], v5 offset:128
  ds_read_b64_tr_b16 v[92:93], v5 offset:1024
  ds_read_b64_tr_b16 v[94:95], v5 offset:1152
  ds_read_b64_tr_b16 v[96:97], v5 offset:2048
  ds_read_b64_tr_b16 v[98:99], v5 offset:2176
  ds_read_b64_tr_b16 v[100:101], v5 offset:3072
  ds_read_b64_tr_b16 v[102:103], v5 offset:3200
  ds_read_b64_tr_b16 v[104:105], v5 offset:4096
  ds_read_b64_tr_b16 v[106:107], v5 offset:4224
  ds_read_b64_tr_b16 v[108:109], v5 offset:5120
  ds_read_b64_tr_b16 v[110:111], v5 offset:5248
  ds_read_b64_tr_b16 v[112:113], v5 offset:6144
  ds_read_b64_tr_b16 v[114:115], v5 offset:6272
  s_waitcnt lgkmcnt(0)
  ds_read_b64_tr_b16 v[116:117], v5 offset:7168
  ds_read_b64_tr_b16 v[118:119], v5 offset:7296
  ds_read_b64_tr_b16 v[120:121], v5 offset:8192
  ds_read_b64_tr_b16 v[122:123], v5 offset:8320
  ds_read_b64_tr_b16 v[124:125], v5 offset:9216
  ds_read_b64_tr_b16 v[126:127], v5 offset:9344
  ds_read_b64_tr_b16 v[128:129], v5 offset:10240
  ds_read_b64_tr_b16 v[130:131], v5 offset:10368
  ds_read_b64_tr_b16 v[132:133], v5 offset:11264
  ds_read_b64_tr_b16 v[134:135], v5 offset:11392
  ds_read_b64_tr_b16 v[136:137], v5 offset:12288
  ds_read_b64_tr_b16 v[138:139], v5 offset:12416
  ds_read_b64_tr_b16 v[140:141], v5 offset:13312
  ds_read_b64_tr_b16 v[142:143], v5 offset:13440
  v_and_b32 v24, 7, v0
  v_mul_u32_u24 v25, 896, v24
  v_lshlrev_b32 v26, 3, v3
  v_add_u32 v25, v25, v26
  s_lshl_b32 s64, s69, 5
  s_add_u32 s65, s64, 655360
  s_and_b32 s64, s34, 0
  s_lshl_b32 s64, s64, 13
  s_add_u32 s65, s65, s64
  s_mov_b32 s71, 262144
L_p_54:
  buffer_load_dwordx2 v[16:17], v25, s[44:47], s65 offen sc1
  s_waitcnt vmcnt(0)
  v_max_u32 v60, v16, v17
  v_cmp_eq_u32 vcc, -1, v60
  s_cbranch_vccz L_pd_55
  s_sub_u32 s71, s71, 1
  s_cmp_eq_u32 s71, 0
  s_cbranch_scc1 L_pd_55
  s_sleep 2
  s_branch L_p_54
L_pd_55:
  s_mul_i32 s64, s40, 7168
  s_add_u32 s64, s64, 294912
  s_add_u32 s65, s64, 4096
  s_mov_b32 exec_lo, 0x00ff00ff
  s_mov_b32 exec_hi, 0x00ff00ff
  s_mov_b32 s71, 262144
L_p_56:
  buffer_load_dwordx4 v[144:147], v64, s[44:47], s64 offen offset:0 sc1
  buffer_load_dwordx4 v[148:151], v64, s[44:47], s64 offen offset:512 sc1
  buffer_load_dwordx4 v[152:155], v64, s[44:47], s64 offen offset:1024 sc1
  buffer_load_dwordx4 v[156:159], v64, s[44:47], s64 offen offset:1536 sc1
  buffer_load_dwordx4 v[160:163], v64, s[44:47], s64 offen offset:2048 sc1
  buffer_load_dwordx4 v[164:167], v64, s[44:47], s64 offen offset:2560 sc1
  buffer_load_dwordx4 v[168:171], v64, s[44:47], s64 offen offset:3072 sc1
  buffer_load_dwordx4 v[172:175], v64, s[44:47], s64 offen offset:3584 sc1
  buffer_load_dwordx4 v[176:179], v64, s[44:47], s65 offen offset:0 sc1
  buffer_load_dwordx4 v[180:183], v64, s[44:47], s65 offen offset:512 sc1
  buffer_load_dwordx4 v[184:187], v64, s[44:47], s65 offen offset:1024 sc1
  buffer_load_dwordx4 v[188:191], v64, s[44:47], s65 offen offset:1536 sc1
  buffer_load_dwordx4 v[192:195], v64, s[44:47], s65 offen offset:2048 sc1
  buffer_load_dwordx4 v[196:199], v64, s[44:47], s65 offen offset:2560 sc1
  s_waitcnt vmcnt(0)
  v_max3_u32 v60, v144, v145, v146
  v_max3_u32 v60, v60, v147, v148
  v_max3_u32 v60, v60, v149, v150
  v_max3_u32 v60, v60, v151, v152
  v_max3_u32 v60, v60, v153, v154
  v_max3_u32 v60, v60, v155, v156
  v_max3_u32 v60, v60, v157, v158
  v_max3_u32 v60, v60, v159, v160
  v_max3_u32 v60, v60, v161, v162
  v_max3_u32 v60, v60, v163, v164
  v_max3_u32 v60, v60, v165, v166
  v_max3_u32 v60, v60, v167, v168
  v_max3_u32 v60, v60, v169, v170
  v_max3_u32 v60, v60, v171, v172
  v_max3_u32 v60, v60, v173, v174
  v_max3_u32 v60, v60, v175, v176
  v_max3_u32 v60, v60, v177, v178
  v_max3_u32 v60, v60, v179, v180
  v_max3_u32 v60, v60, v181, v182
  v_max3_u32 v60, v60, v183, v184
  v_max3_u32 v60, v60, v185, v186
  v_max3_u32 v60, v60, v187, v188
  v_max3_u32 v60, v60, v189, v190
  v_max3_u32 v60, v60, v191, v192
  v_max3_u32 v60, v60, v193, v194
  v_max3_u32 v60, v60, v195, v196
  v_max3_u32 v60, v60, v197, v198
  v_max_u32 v60, v60, v199
  v_cmp_eq_u32 vcc, -1, v60
  s_cbranch_vccz L_pd_57
  s_sub_u32 s71, s71, 1
  s_cmp_eq_u32 s71, 0
  s_cbranch_scc1 L_pd_57
  s_branch L_p_56
L_pd_57:
  s_mov_b64 exec, -1
  s_waitcnt lgkmcnt(0)
  v_mfma_f32_16x16x32_bf16 v[32:35], v[88:91], v[144:147], 0
  v_mfma_f32_16x16x32_bf16 v[32:35], v[92:95], v[148:151], v[32:35]
  v_mfma_f32_16x16x32_bf16 v[32:35], v[96:99], v[152:155], v[32:35]
  v_mfma_f32_16x16x32_bf16 v[32:35], v[100:103], v[156:159], v[32:35]
  v_mfma_f32_16x16x32_bf16 v[32:35], v[104:107], v[160:163], v[32:35]
  v_mfma_f32_16x16x32_bf16 v[32:35], v[108:111], v[164:167], v[32:35]
  v_mfma_f32_16x16x32_bf16 v[32:35], v[112:115], v[168:171], v[32:35]
  v_mfma_f32_16x16x32_bf16 v[32:35], v[116:119], v[172:175], v[32:35]
  v_mfma_f32_16x16x32_bf16 v[32:35], v[120:123], v[176:179], v[32:35]
  v_mfma_f32_16x16x32_bf16 v[32:35], v[124:127], v[180:183], v[32:35]
  v_mfma_f32_16x16x32_bf16 v[32:35], v[128:131], v[184:187], v[32:35]
  v_mfma_f32_16x16x32_bf16 v[32:35], v[132:135], v[188:191], v[32:35]
  v_mfma_f32_16x16x32_bf16 v[32:35], v[136:139], v[192:195], v[32:35]
  v_mfma_f32_16x16x32_bf16 v[32:35], v[140:143], v[196:199], v[32:35]
  s_lshl_b32 s64, s40, 10
  v_add_u32 v50, s64, v9
  s_nop 5
  ds_write_b128 v50, v[32:35] offset:11648
  s_waitcnt lgkmcnt(0)
  s_barrier
  s_cmp_lg_u32 s40, 0
  s_cbranch_scc1 L_FIN
  ds_read_b128 v[32:35], v9 offset:11648
  ds_read_b128 v[36:39], v9 offset:12672
  ds_read_b128 v[40:43], v9 offset:13696
  ds_read_b128 v[44:47], v9 offset:14720
  s_waitcnt lgkmcnt(0)
  v_add_f32 v48, v32, v36
  v_add_f32 v48, v48, v40
  v_add_f32 v48, v48, v44
  v_add_f32 v49, v33, v37
  v_add_f32 v49, v49, v41
  v_add_f32 v49, v49, v45
  v_add_f32 v50, v34, v38
  v_add_f32 v50, v50, v42
  v_add_f32 v50, v50, v46
  v_add_f32 v51, v35, v39
  v_add_f32 v51, v51, v43
  v_add_f32 v51, v51, v47
  v_cvt_pk_bf16_f32 v32, v48, v49
  v_cvt_pk_bf16_f32 v33, v50, v51
  v_lshlrev_b32 v48, 16, v32
  v_and_b32 v49, 0xffff0000, v32
  v_lshlrev_b32 v50, 16, v33
  v_and_b32 v51, 0xffff0000, v33
  v_lshlrev_b32 v52, 16, v68
  v_and_b32 v53, 0xffff0000, v68
  v_lshlrev_b32 v54, 16, v70
  v_and_b32 v55, 0xffff0000, v70
  v_mul_f32 v48, v48, v52
  v_mul_f32 v49, v49, v53
  v_mul_f32 v50, v50, v54
  v_mul_f32 v51, v51, v55
  v_cvt_pk_bf16_f32 v32, v48, v49
  v_cvt_pk_bf16_f32 v33, v50, v51
  v_lshlrev_b32 v48, 16, v32
  v_and_b32 v49, 0xffff0000, v32
  v_lshlrev_b32 v50, 16, v33
  v_and_b32 v51, 0xffff0000, v33
  v_lshlrev_b32 v52, 16, v16
  v_and_b32 v53, 0xffff0000, v16
  v_lshlrev_b32 v54, 16, v17
  v_and_b32 v55, 0xffff0000, v17
  v_add_f32 v48, v48, v52
  v_add_f32 v49, v49, v53
  v_add_f32 v50, v50, v54
  v_add_f32 v51, v51, v55
  v_cvt_pk_bf16_f32 v32, v48, v49
  v_cvt_pk_bf16_f32 v33, v50, v51
  s_mov_b32 s56, s26
  s_mov_b32 s57, s27
  s_mov_b32 s58, 7168
  s_mov_b32 s59, 0x20000
  v_mul_u32_u24 v25, 896, v4
  v_lshlrev_b32 v26, 3, v3
  v_add_u32 v25, v25, v26
  s_lshl_b32 s64, s69, 5
  s_mov_b32 exec_lo, 0x00ff00ff
  s_mov_b32 exec_hi, 0x00ff00ff
  buffer_store_dwordx2 v[32:33], v25, s[56:59], s64 offen
  s_mov_b64 exec, -1
  s_cmp_lg_u32 s69, 0
  s_cbranch_scc1 L_noep
  s_add_u32 s64, s32, 1
  v_mov_b32 v24, s64
  v_mov_b32 v25, 0
  s_mov_b64 exec, 1
  buffer_store_dword v24, v25, s[44:47], 0 offen
  s_mov_b64 exec, -1
L_noep:
L_FIN:
L_END:
  s_endpgm
L_CODE_END:
.section .rodata,"a"
.p2align 6
.amdhsa_kernel adaLN_cond__mha_block_cached__geglu_ffn__decode_kernel
  .amdhsa_next_free_vgpr 256
  .amdhsa_next_free_sgpr 102
  .amdhsa_accum_offset 256
  .amdhsa_group_segment_fixed_size 0
  .amdhsa_kernarg_size 112
  .amdhsa_user_sgpr_count 2
  .amdhsa_user_sgpr_kernarg_segment_ptr 1
  .amdhsa_system_sgpr_workgroup_id_x 1
  .amdhsa_float_denorm_mode_32 3
.end_amdhsa_kernel
```
